```python
import torch

def _softmax(x, axis=-1):
    return torch.softmax(x, dim=axis)

def _gelu(x):
    return torch.nn.functional.gelu(x, approximate='tanh')

def _silu(x):
    return torch.nn.functional.silu(x)

def _sigmoid(x):
    return torch.sigmoid(x)

def _layernorm(x, axis=-1, eps=1e-05):
    m = x.mean(dim=axis, keepdim=True)
    v = x.var(dim=axis, keepdim=True, unbiased=False)
    return (x - m) / torch.sqrt(v + eps)

def _scatter_add(tgt, idx, src, axis=0):
    return tgt.clone().index_add_(axis, idx, src)

def _segment_sum(src, seg, n):
    out = torch.zeros((n,) + src.shape[1:], dtype=src.dtype)
    return out.index_add_(0, seg, src)

def _pad(x, pw):
    flat = tuple((v for pair in reversed(pw) for v in pair))
    return torch.nn.functional.pad(x, flat)
kernel_name = 'standalone__swin_window_attn__vision'

def setup_inputs():

    _w = lambda a: (lambda t: t.to(torch.bfloat16) if t.is_floating_point() else t)(torch.as_tensor(a))
    H = W = 384 // 8 * 8
    C, win = (192, 8)
    return {'x': _w((lambda *s: torch.randn(*s, dtype=torch.bfloat16) * 0.2)(1, H, W, C)), 'wqkv': _w((lambda *s: torch.randn(*s, dtype=torch.bfloat16) * 0.2)(C, 3 * C)), 'wo': _w((lambda *s: torch.randn(*s, dtype=torch.bfloat16) * 0.05)(C, C))}

def reference(x, wqkv, wo):
    B, H, W, C = x.shape
    win = 8
    nh, nw = (H // win, W // win)
    xw = (lambda x, *d: x.permute(*d))(x.reshape(B, nh, win, nw, win, C), 0, 1, 3, 2, 4, 5)
    xw = xw.reshape(B * nh * nw, win * win, C)
    qkv = xw @ wqkv
    q, k, v = (qkv[..., :C].clone(), qkv[..., C:2 * C].clone(), qkv[..., 2 * C:].clone())
    scale = C ** (-0.5)
    p = _softmax(torch.einsum('bqc,bkc->bqk', q, k) * scale, axis=-1)
    o = torch.einsum('bqk,bkc->bqc', p, v) @ wo
    o = (lambda x, *d: x.permute(*d))(o.reshape(B, nh, nw, win, win, C), 0, 1, 3, 2, 4, 5)
    return o.reshape(B, H, W, C)
```

```asm
; @launch kernel=swin_fold_kernel grid=(144,1,1) block=(64,1,1) lds=0
; @launch kernel=standalone__swin_window_attn__vision_kernel grid=(256,1,1) block=(256,1,1) lds=163840
.amdgcn_target "amdgcn-amd-amdhsa--gfx950"
.text
.globl standalone__swin_window_attn__vision_kernel
.p2align 8
.type standalone__swin_window_attn__vision_kernel,@function
standalone__swin_window_attn__vision_kernel:
    s_cmp_ge_u32 s2, 256
    s_cbranch_scc1 L_end
    s_load_dwordx2 s[4:5], s[0:1], 0
    s_load_dwordx2 s[6:7], s[0:1], 24
    s_load_dwordx2 s[24:25], s[0:1], 40
    v_lshrrev_b32 v244, 6, v0
    v_and_b32 v250, 63, v0
    v_readfirstlane_b32 s20, v244
    v_lshrrev_b32 v251, 4, v250
    v_and_b32 v252, 15, v250
    v_lshrrev_b32 v253, 1, v252
    v_mul_u32_u24 v244, 384, v252
    v_add_u32 v245, 0, v251
    v_xor_b32 v245, v245, v253
    v_lshlrev_b32 v245, 4, v245
    v_add_u32 v246, v244, v245
    v_add_u32 v246, 40960, v246
    v_add_u32 v245, 4, v251
    v_xor_b32 v245, v245, v253
    v_lshlrev_b32 v245, 4, v245
    v_add_u32 v247, v244, v245
    v_add_u32 v247, 40960, v247
    s_mul_i32 s22, s2, 1
    s_mov_b32 s21, 0
    s_mov_b32 s23, 0
    s_mov_b32 s39, 24576
    s_mov_b32 s27, 0x3dd53b95
    s_mov_b32 s28, 0xbdd53b95
    s_waitcnt lgkmcnt(0)
    s_mov_b32 s8, s4
    s_and_b32 s9, s5, 0xffff
    s_mov_b32 s10, 56623104
    s_mov_b32 s11, 0x00020000
    s_mov_b32 s12, s6
    s_and_b32 s13, s7, 0xffff
    s_mov_b32 s14, 56623104
    s_mov_b32 s15, 0x00020000
    s_mov_b32 s16, s24
    s_and_b32 s17, s25, 0xffff
    s_mov_b32 s18, 147456
    s_mov_b32 s19, 0x00020000
    s_cmp_ge_u32 s20, 2
    s_cbranch_scc1 L_owave
    v_lshlrev_b32 v210, 4, v250
    s_mul_i32 s30, s20, 12288
    s_sub_u32 s31, 12288, s30
    v_add_u32 v194, s30, v246
    v_add_u32 v192, s31, v246
    v_add_u32 v195, s30, v247
    v_add_u32 v193, s31, v247
    s_mul_i32 s30, s20, 5120
    s_add_u32 s30, s30, 0
    v_add_u32 v196, s30, v210
    s_mul_i32 s30, s20, 3072
    s_add_u32 s30, s30, 1024
    v_add_u32 v197, s30, v210
    s_lshl_b32 s29, s20, 2
    v_add_u32 v244, 0, v250
    v_mul_u32_u24 v244, 2731, v244
    v_lshrrev_b32 v244, 17, v244
    v_or_b32 v244, s29, v244
    v_xor_b32 v244, v244, v250
    v_lshlrev_b32 v216, 4, v244
    v_add_u32 v244, 64, v250
    v_mul_u32_u24 v244, 2731, v244
    v_lshrrev_b32 v244, 17, v244
    v_or_b32 v244, s29, v244
    v_xor_b32 v244, v244, v250
    v_lshlrev_b32 v217, 4, v244
    v_add_u32 v244, 128, v250
    v_mul_u32_u24 v244, 2731, v244
    v_lshrrev_b32 v244, 17, v244
    v_or_b32 v244, s29, v244
    v_xor_b32 v244, v244, v250
    v_lshlrev_b32 v218, 4, v244
    s_mul_i32 s38, s20, 147456
    s_mul_i32 s34, s20, 3072
    s_add_u32 s34, s34, 40960
    s_mov_b32 s35, 0
    s_add_u32 s34, s34, 24576
    s_mov_b32 s35, 1
    v_add_u32 v208, 16384, v210
    v_add_u32 v209, 114688, v210
    s_lshl_b32 s49, s20, 10
    s_add_u32 s36, s49, 16384
    s_add_u32 s37, s49, 0
    s_mov_b32 m0, s36
    s_nop 0
    buffer_load_dwordx4 v210, s[16:19], s37 offen offset:0 lds
    s_add_u32 s36, s49, 18432
    s_add_u32 s37, s49, 2048
    s_mov_b32 m0, s36
    s_nop 0
    buffer_load_dwordx4 v210, s[16:19], s37 offen offset:0 lds
    s_add_u32 s36, s49, 20480
    s_add_u32 s37, s49, 4096
    s_mov_b32 m0, s36
    s_nop 0
    buffer_load_dwordx4 v210, s[16:19], s37 offen offset:0 lds
    s_add_u32 s36, s49, 22528
    s_add_u32 s37, s49, 6144
    s_mov_b32 m0, s36
    s_nop 0
    buffer_load_dwordx4 v210, s[16:19], s37 offen offset:0 lds
    s_add_u32 s36, s49, 24576
    s_add_u32 s37, s49, 8192
    s_mov_b32 m0, s36
    s_nop 0
    buffer_load_dwordx4 v210, s[16:19], s37 offen offset:0 lds
    s_add_u32 s36, s49, 26624
    s_add_u32 s37, s49, 10240
    s_mov_b32 m0, s36
    s_nop 0
    buffer_load_dwordx4 v210, s[16:19], s37 offen offset:0 lds
    s_add_u32 s36, s49, 28672
    s_add_u32 s37, s49, 12288
    s_mov_b32 m0, s36
    s_nop 0
    buffer_load_dwordx4 v210, s[16:19], s37 offen offset:0 lds
    s_add_u32 s36, s49, 30720
    s_add_u32 s37, s49, 14336
    s_mov_b32 m0, s36
    s_nop 0
    buffer_load_dwordx4 v210, s[16:19], s37 offen offset:0 lds
    s_add_u32 s36, s49, 32768
    s_add_u32 s37, s49, 16384
    s_mov_b32 m0, s36
    s_nop 0
    buffer_load_dwordx4 v210, s[16:19], s37 offen offset:0 lds
    s_add_u32 s36, s49, 34816
    s_add_u32 s37, s49, 18432
    s_mov_b32 m0, s36
    s_nop 0
    buffer_load_dwordx4 v210, s[16:19], s37 offen offset:0 lds
    s_add_u32 s36, s49, 36864
    s_add_u32 s37, s49, 20480
    s_mov_b32 m0, s36
    s_nop 0
    buffer_load_dwordx4 v210, s[16:19], s37 offen offset:0 lds
    s_add_u32 s36, s49, 38912
    s_add_u32 s37, s49, 22528
    s_mov_b32 m0, s36
    s_nop 0
    buffer_load_dwordx4 v210, s[16:19], s37 offen offset:0 lds
    s_add_u32 s36, s49, 139264
    s_add_u32 s37, s49, 49152
    s_mov_b32 m0, s36
    s_nop 0
    buffer_load_dwordx4 v210, s[16:19], s37 offen offset:0 lds
    s_add_u32 s36, s49, 141312
    s_add_u32 s37, s49, 51200
    s_mov_b32 m0, s36
    s_nop 0
    buffer_load_dwordx4 v210, s[16:19], s37 offen offset:0 lds
    s_add_u32 s36, s49, 143360
    s_add_u32 s37, s49, 53248
    s_mov_b32 m0, s36
    s_nop 0
    buffer_load_dwordx4 v210, s[16:19], s37 offen offset:0 lds
    s_add_u32 s36, s49, 145408
    s_add_u32 s37, s49, 55296
    s_mov_b32 m0, s36
    s_nop 0
    buffer_load_dwordx4 v210, s[16:19], s37 offen offset:0 lds
    s_add_u32 s36, s49, 147456
    s_add_u32 s37, s49, 57344
    s_mov_b32 m0, s36
    s_nop 0
    buffer_load_dwordx4 v210, s[16:19], s37 offen offset:0 lds
    s_add_u32 s36, s49, 149504
    s_add_u32 s37, s49, 59392
    s_mov_b32 m0, s36
    s_nop 0
    buffer_load_dwordx4 v210, s[16:19], s37 offen offset:0 lds
    s_add_u32 s36, s49, 151552
    s_add_u32 s37, s49, 61440
    s_mov_b32 m0, s36
    s_nop 0
    buffer_load_dwordx4 v210, s[16:19], s37 offen offset:0 lds
    s_add_u32 s36, s49, 153600
    s_add_u32 s37, s49, 63488
    s_mov_b32 m0, s36
    s_nop 0
    buffer_load_dwordx4 v210, s[16:19], s37 offen offset:0 lds
    s_add_u32 s36, s49, 155648
    s_add_u32 s37, s49, 65536
    s_mov_b32 m0, s36
    s_nop 0
    buffer_load_dwordx4 v210, s[16:19], s37 offen offset:0 lds
    s_add_u32 s36, s49, 157696
    s_add_u32 s37, s49, 67584
    s_mov_b32 m0, s36
    s_nop 0
    buffer_load_dwordx4 v210, s[16:19], s37 offen offset:0 lds
    s_add_u32 s36, s49, 159744
    s_add_u32 s37, s49, 69632
    s_mov_b32 m0, s36
    s_nop 0
    buffer_load_dwordx4 v210, s[16:19], s37 offen offset:0 lds
    s_add_u32 s36, s49, 161792
    s_add_u32 s37, s49, 71680
    s_mov_b32 m0, s36
    s_nop 0
    buffer_load_dwordx4 v210, s[16:19], s37 offen offset:0 lds
    s_waitcnt vmcnt(12)
    s_barrier
    ds_read_b128 v[120:123], v194 offset:0
    ds_read_b128 a[0:3], v208 offset:0
    ds_read_b128 v[124:127], v195 offset:0
    ds_read_b128 a[4:7], v208 offset:1024
    ds_read_b128 v[128:131], v194 offset:128
    ds_read_b128 a[8:11], v208 offset:2048
    ds_read_b128 v[132:135], v195 offset:128
    ds_read_b128 a[12:15], v208 offset:3072
    ds_read_b128 v[136:139], v194 offset:256
    ds_read_b128 a[16:19], v208 offset:4096
    ds_read_b128 v[140:143], v195 offset:256
    ds_read_b128 a[20:23], v208 offset:5120
    ds_read_b128 v[144:147], v194 offset:6144
    ds_read_b128 v[148:151], v195 offset:6144
    ds_read_b128 v[152:155], v194 offset:6272
    s_waitcnt lgkmcnt(13)
    v_mfma_f32_16x16x32_bf16 v[0:3], a[0:3], v[120:123], 0
    ds_read_b128 v[156:159], v195 offset:6272
    s_waitcnt lgkmcnt(12)
    v_mfma_f32_16x16x32_bf16 v[0:3], a[4:7], v[124:127], v[0:3]
    ds_read_b128 v[160:163], v194 offset:6400
    s_waitcnt lgkmcnt(11)
    v_mfma_f32_16x16x32_bf16 v[0:3], a[8:11], v[128:131], v[0:3]
    ds_read_b128 v[164:167], v195 offset:6400
    s_waitcnt lgkmcnt(10)
    v_mfma_f32_16x16x32_bf16 v[0:3], a[12:15], v[132:135], v[0:3]
    ds_read_b128 a[24:27], v208 offset:6144
    s_waitcnt lgkmcnt(9)
    v_mfma_f32_16x16x32_bf16 v[0:3], a[16:19], v[136:139], v[0:3]
    ds_read_b128 a[28:31], v208 offset:7168
    s_waitcnt lgkmcnt(8)
    v_mfma_f32_16x16x32_bf16 v[0:3], a[20:23], v[140:143], v[0:3]
    ds_read_b128 a[32:35], v208 offset:8192
    s_waitcnt lgkmcnt(8)
    v_mfma_f32_16x16x32_bf16 v[4:7], a[0:3], v[144:147], 0
    ds_read_b128 a[36:39], v208 offset:9216
    s_waitcnt lgkmcnt(8)
    v_mfma_f32_16x16x32_bf16 v[4:7], a[4:7], v[148:151], v[4:7]
    ds_read_b128 a[40:43], v208 offset:10240
    s_waitcnt lgkmcnt(8)
    v_mfma_f32_16x16x32_bf16 v[4:7], a[8:11], v[152:155], v[4:7]
    ds_read_b128 a[44:47], v208 offset:11264
    s_waitcnt lgkmcnt(8)
    v_mfma_f32_16x16x32_bf16 v[4:7], a[12:15], v[156:159], v[4:7]
    s_waitcnt lgkmcnt(7)
    v_mfma_f32_16x16x32_bf16 v[4:7], a[16:19], v[160:163], v[4:7]
    s_waitcnt lgkmcnt(6)
    v_mfma_f32_16x16x32_bf16 v[4:7], a[20:23], v[164:167], v[4:7]
    ds_read_b128 a[48:51], v208 offset:12288
    s_waitcnt lgkmcnt(6)
    v_mfma_f32_16x16x32_bf16 v[8:11], a[24:27], v[120:123], 0
    s_add_u32 s31, s22, 256
    s_mul_hi_u32 s29, s31, 89478486
    s_mul_i32 s30, s29, 48
    s_waitcnt lgkmcnt(5)
    v_mfma_f32_16x16x32_bf16 v[8:11], a[28:31], v[124:127], v[8:11]
    s_sub_u32 s30, s31, s30
    s_mul_i32 s29, s29, 1179648
    s_mul_i32 s30, s30, 3072
    s_add_u32 s32, s29, s30
    s_waitcnt lgkmcnt(4)
    v_mfma_f32_16x16x32_bf16 v[8:11], a[32:35], v[128:131], v[8:11]
    s_add_u32 s32, s32, s38
    s_add_u32 s36, s34, 0
    s_add_u32 s37, s32, 0
    s_mov_b32 m0, s36
    s_waitcnt lgkmcnt(3)
    v_mfma_f32_16x16x32_bf16 v[8:11], a[36:39], v[132:135], v[8:11]
    buffer_load_dwordx4 v216, s[8:11], s37 offen offset:0 nt lds
    s_waitcnt lgkmcnt(2)
    v_mfma_f32_16x16x32_bf16 v[8:11], a[40:43], v[136:139], v[8:11]
    ds_read_b128 a[52:55], v208 offset:13312
    s_waitcnt lgkmcnt(2)
    v_mfma_f32_16x16x32_bf16 v[8:11], a[44:47], v[140:143], v[8:11]
    ds_read_b128 a[56:59], v208 offset:14336
    ds_read_b128 a[60:63], v208 offset:15360
    v_mfma_f32_16x16x32_bf16 v[12:15], a[24:27], v[144:147], 0
    buffer_load_dwordx4 v217, s[8:11], s37 offen offset:1024 nt lds
    v_mfma_f32_16x16x32_bf16 v[12:15], a[28:31], v[148:151], v[12:15]
    ds_read_b128 a[64:67], v208 offset:16384
    v_mfma_f32_16x16x32_bf16 v[12:15], a[32:35], v[152:155], v[12:15]
    ds_read_b128 a[68:71], v208 offset:17408
    v_mfma_f32_16x16x32_bf16 v[12:15], a[36:39], v[156:159], v[12:15]
    s_add_u32 s36, s34, 6144
    v_mfma_f32_16x16x32_bf16 v[12:15], a[40:43], v[160:163], v[12:15]
    buffer_load_dwordx4 v218, s[8:11], s37 offen offset:2048 nt lds
    v_mfma_f32_16x16x32_bf16 v[12:15], a[44:47], v[164:167], v[12:15]
    s_add_u32 s37, s32, 294912
    s_mov_b32 m0, s36
    s_add_u32 s36, s34, 12288
    s_waitcnt lgkmcnt(5)
    v_mfma_f32_16x16x32_bf16 v[16:19], a[48:51], v[120:123], 0
    buffer_load_dwordx4 v216, s[8:11], s37 offen offset:0 nt lds
    s_waitcnt lgkmcnt(4)
    v_mfma_f32_16x16x32_bf16 v[16:19], a[52:55], v[124:127], v[16:19]
    ds_read_b128 a[72:75], v208 offset:18432
    s_waitcnt lgkmcnt(4)
    v_mfma_f32_16x16x32_bf16 v[16:19], a[56:59], v[128:131], v[16:19]
    ds_read_b128 a[76:79], v208 offset:19456
    ds_read_b128 a[80:83], v208 offset:20480
    s_waitcnt lgkmcnt(5)
    v_mfma_f32_16x16x32_bf16 v[16:19], a[60:63], v[132:135], v[16:19]
    ds_read_b128 a[84:87], v208 offset:21504
    s_waitcnt lgkmcnt(5)
    v_mfma_f32_16x16x32_bf16 v[16:19], a[64:67], v[136:139], v[16:19]
    buffer_load_dwordx4 v217, s[8:11], s37 offen offset:1024 nt lds
    s_waitcnt lgkmcnt(4)
    v_mfma_f32_16x16x32_bf16 v[16:19], a[68:71], v[140:143], v[16:19]
    ds_read_b128 a[88:91], v208 offset:22528
    v_mfma_f32_16x16x32_bf16 v[20:23], a[48:51], v[144:147], 0
    ds_read_b128 a[92:95], v208 offset:23552
    ds_read_b128 v[168:171], v192 offset:0
    v_mfma_f32_16x16x32_bf16 v[20:23], a[52:55], v[148:151], v[20:23]
    ds_read_b128 v[172:175], v192 offset:6144
    v_mfma_f32_16x16x32_bf16 v[20:23], a[56:59], v[152:155], v[20:23]
    buffer_load_dwordx4 v218, s[8:11], s37 offen offset:2048 nt lds
    v_mfma_f32_16x16x32_bf16 v[20:23], a[60:63], v[156:159], v[20:23]
    s_add_u32 s37, s32, 589824
    s_mov_b32 m0, s36
    s_add_u32 s36, s34, 18432
    v_mfma_f32_16x16x32_bf16 v[20:23], a[64:67], v[160:163], v[20:23]
    buffer_load_dwordx4 v216, s[8:11], s37 offen offset:0 nt lds
    v_mfma_f32_16x16x32_bf16 v[20:23], a[68:71], v[164:167], v[20:23]
    v_cvt_pk_bf16_f32 v96, v0, v1
    s_waitcnt lgkmcnt(7)
    v_mfma_f32_16x16x32_bf16 v[24:27], a[72:75], v[120:123], 0
    s_add_u32 s23, s23, 1
    s_cmp_eq_u32 s23, 5
    s_cselect_b32 s26, 4294868992, s39
    s_cselect_b32 s23, 0, s23
    s_waitcnt lgkmcnt(6)
    v_mfma_f32_16x16x32_bf16 v[24:27], a[76:79], v[124:127], v[24:27]
    v_cvt_pk_bf16_f32 v97, v2, v3
    s_waitcnt lgkmcnt(5)
    v_mfma_f32_16x16x32_bf16 v[24:27], a[80:83], v[128:131], v[24:27]
    buffer_load_dwordx4 v217, s[8:11], s37 offen offset:1024 nt lds
    s_waitcnt lgkmcnt(4)
    v_mfma_f32_16x16x32_bf16 v[24:27], a[84:87], v[132:135], v[24:27]
    v_cvt_pk_bf16_f32 v98, v8, v9
    s_waitcnt lgkmcnt(3)
    v_mfma_f32_16x16x32_bf16 v[24:27], a[88:91], v[136:139], v[24:27]
    buffer_load_dwordx4 v218, s[8:11], s37 offen offset:2048 nt lds
    s_waitcnt lgkmcnt(2)
    v_mfma_f32_16x16x32_bf16 v[24:27], a[92:95], v[140:143], v[24:27]
    v_cvt_pk_bf16_f32 v99, v10, v11
    s_add_u32 s37, s32, 884736
    v_mfma_f32_16x16x32_bf16 v[28:31], a[72:75], v[144:147], 0
    s_mov_b32 m0, s36
    v_cvt_pk_bf16_f32 v100, v4, v5
    v_mfma_f32_16x16x32_bf16 v[28:31], a[76:79], v[148:151], v[28:31]
    buffer_load_dwordx4 v216, s[8:11], s37 offen offset:0 nt lds
    v_mfma_f32_16x16x32_bf16 v[28:31], a[80:83], v[152:155], v[28:31]
    v_cvt_pk_bf16_f32 v101, v6, v7
    v_mfma_f32_16x16x32_bf16 v[28:31], a[84:87], v[156:159], v[28:31]
    v_cvt_pk_bf16_f32 v102, v12, v13
    v_cvt_pk_bf16_f32 v103, v14, v15
    v_mfma_f32_16x16x32_bf16 v[28:31], a[88:91], v[160:163], v[28:31]
    ds_read_b128 v[184:187], v195 offset:256
    v_mfma_f32_16x16x32_bf16 v[28:31], a[92:95], v[164:167], v[28:31]
    ds_read_b128 v[188:191], v195 offset:6400
    ds_read_b128 v[176:179], v193 offset:0
    v_mfma_f32_16x16x32_bf16 v[32:35], v[120:123], v[96:99], 0
    ds_read_b128 v[180:183], v193 offset:6144
    s_waitcnt lgkmcnt(5)
    v_mfma_f32_16x16x32_bf16 v[48:51], v[168:171], v[96:99], 0
    buffer_load_dwordx4 v217, s[8:11], s37 offen offset:1024 nt lds
    v_mfma_f32_16x16x32_bf16 v[40:43], v[120:123], v[100:103], 0
    v_add_u32 v194, s26, v194
    v_mfma_f32_16x16x32_bf16 v[56:59], v[168:171], v[100:103], 0
    v_add_u32 v195, s26, v195
    ds_read_b128 v[168:171], v192 offset:128
    v_mfma_f32_16x16x32_bf16 v[36:39], v[144:147], v[96:99], 0
    s_waitcnt lgkmcnt(5)
    v_mfma_f32_16x16x32_bf16 v[52:55], v[172:175], v[96:99], 0
    buffer_load_dwordx4 v218, s[8:11], s37 offen offset:2048 nt lds
    v_mfma_f32_16x16x32_bf16 v[44:47], v[144:147], v[100:103], 0
    s_add_u32 s35, s35, 1
    s_add_u32 s34, s34, 24576
    s_cmp_eq_u32 s35, 5
    s_cselect_b32 s35, 0, s35
    s_cselect_b32 s29, 122880, 0
    s_sub_u32 s34, s34, s29
    v_mfma_f32_16x16x32_bf16 v[60:63], v[172:175], v[100:103], 0
    ds_read_b128 v[172:175], v192 offset:6272
    s_waitcnt lgkmcnt(0)
    s_barrier
    ds_read_b128 a[96:99], v209 offset:0
    ds_read_b128 a[100:103], v209 offset:1024
    v_cvt_pk_bf16_f32 v104, v16, v17
    v_cvt_pk_bf16_f32 v105, v18, v19
    v_cvt_pk_bf16_f32 v106, v24, v25
    v_cvt_pk_bf16_f32 v107, v26, v27
    v_cvt_pk_bf16_f32 v108, v20, v21
    v_cvt_pk_bf16_f32 v109, v22, v23
    v_mfma_f32_16x16x32_bf16 v[32:35], v[124:127], v[104:107], v[32:35]
    v_cvt_pk_bf16_f32 v110, v28, v29
    v_cvt_pk_bf16_f32 v111, v30, v31
    v_mfma_f32_16x16x32_bf16 v[48:51], v[176:179], v[104:107], v[48:51]
    ds_read_b128 a[104:107], v209 offset:2048
    v_mfma_f32_16x16x32_bf16 v[40:43], v[124:127], v[108:111], v[40:43]
    ds_read_b128 a[108:111], v209 offset:3072
    v_mfma_f32_16x16x32_bf16 v[56:59], v[176:179], v[108:111], v[56:59]
    ds_read_b128 a[112:115], v209 offset:4096
    v_mfma_f32_16x16x32_bf16 v[36:39], v[148:151], v[104:107], v[36:39]
    ds_read_b128 a[116:119], v209 offset:5120
    v_mfma_f32_16x16x32_bf16 v[52:55], v[180:183], v[104:107], v[52:55]
    v_mfma_f32_16x16x32_bf16 v[44:47], v[148:151], v[108:111], v[44:47]
    v_mfma_f32_16x16x32_bf16 v[60:63], v[180:183], v[108:111], v[60:63]
    s_waitcnt lgkmcnt(5)
    v_mfma_f32_16x16x32_bf16 v[0:3], a[96:99], v[120:123], 0
    ds_read_b128 a[120:123], v209 offset:6144
    s_waitcnt lgkmcnt(5)
    v_mfma_f32_16x16x32_bf16 v[0:3], a[100:103], v[124:127], v[0:3]
    ds_read_b128 a[124:127], v209 offset:7168
    ds_read_b128 a[128:131], v209 offset:8192
    s_waitcnt lgkmcnt(6)
    v_mfma_f32_16x16x32_bf16 v[0:3], a[104:107], v[128:131], v[0:3]
    s_add_u32 s31, s22, 512
    s_mul_hi_u32 s29, s31, 89478486
    s_mul_i32 s30, s29, 48
    s_waitcnt lgkmcnt(5)
    v_mfma_f32_16x16x32_bf16 v[0:3], a[108:111], v[132:135], v[0:3]
    s_sub_u32 s30, s31, s30
    s_mul_i32 s29, s29, 1179648
    s_mul_i32 s30, s30, 3072
    s_add_u32 s32, s29, s30
    s_waitcnt lgkmcnt(4)
    v_mfma_f32_16x16x32_bf16 v[0:3], a[112:115], v[136:139], v[0:3]
    s_add_u32 s32, s32, s38
    s_add_u32 s36, s34, 0
    s_add_u32 s37, s32, 0
    s_mov_b32 m0, s36
    s_waitcnt lgkmcnt(3)
    v_mfma_f32_16x16x32_bf16 v[0:3], a[116:119], v[140:143], v[0:3]
    buffer_load_dwordx4 v216, s[8:11], s37 offen offset:0 nt lds
    v_mfma_f32_16x16x32_bf16 v[4:7], a[96:99], v[144:147], 0
    ds_read_b128 a[132:135], v209 offset:9216
    v_mfma_f32_16x16x32_bf16 v[4:7], a[100:103], v[148:151], v[4:7]
    ds_read_b128 a[136:139], v209 offset:10240
    v_mfma_f32_16x16x32_bf16 v[4:7], a[104:107], v[152:155], v[4:7]
    ds_read_b128 a[140:143], v209 offset:11264
    v_mfma_f32_16x16x32_bf16 v[4:7], a[108:111], v[156:159], v[4:7]
    buffer_load_dwordx4 v217, s[8:11], s37 offen offset:1024 nt lds
    v_mfma_f32_16x16x32_bf16 v[4:7], a[112:115], v[160:163], v[4:7]
    v_mfma_f32_16x16x32_bf16 v[4:7], a[116:119], v[164:167], v[4:7]
    s_waitcnt lgkmcnt(5)
    v_mfma_f32_16x16x32_bf16 v[8:11], a[120:123], v[120:123], 0
    s_waitcnt lgkmcnt(4)
    v_mfma_f32_16x16x32_bf16 v[8:11], a[124:127], v[124:127], v[8:11]
    buffer_load_dwordx4 v218, s[8:11], s37 offen offset:2048 nt lds
    s_waitcnt lgkmcnt(3)
    v_mfma_f32_16x16x32_bf16 v[8:11], a[128:131], v[128:131], v[8:11]
    ds_read_b128 a[144:147], v209 offset:12288
    s_waitcnt lgkmcnt(3)
    v_mfma_f32_16x16x32_bf16 v[8:11], a[132:135], v[132:135], v[8:11]
    ds_read_b128 a[148:151], v209 offset:13312
    ds_read_b128 a[152:155], v209 offset:14336
    s_waitcnt lgkmcnt(4)
    v_mfma_f32_16x16x32_bf16 v[8:11], a[136:139], v[136:139], v[8:11]
    s_add_u32 s36, s34, 6144
    s_add_u32 s37, s32, 294912
    s_mov_b32 m0, s36
    s_waitcnt lgkmcnt(3)
    v_mfma_f32_16x16x32_bf16 v[8:11], a[140:143], v[140:143], v[8:11]
    buffer_load_dwordx4 v216, s[8:11], s37 offen offset:0 nt lds
    v_mfma_f32_16x16x32_bf16 v[12:15], a[120:123], v[144:147], 0
    ds_read_b128 a[156:159], v209 offset:15360
    v_mfma_f32_16x16x32_bf16 v[12:15], a[124:127], v[148:151], v[12:15]
    ds_read_b128 a[160:163], v209 offset:16384
    v_mfma_f32_16x16x32_bf16 v[12:15], a[128:131], v[152:155], v[12:15]
    ds_read_b128 a[164:167], v209 offset:17408
    v_mfma_f32_16x16x32_bf16 v[12:15], a[132:135], v[156:159], v[12:15]
    buffer_load_dwordx4 v217, s[8:11], s37 offen offset:1024 nt lds
    v_mfma_f32_16x16x32_bf16 v[12:15], a[136:139], v[160:163], v[12:15]
    v_mfma_f32_16x16x32_bf16 v[12:15], a[140:143], v[164:167], v[12:15]
    ds_read_b128 a[168:171], v209 offset:18432
    s_waitcnt lgkmcnt(6)
    v_mfma_f32_16x16x32_bf16 v[16:19], a[144:147], v[120:123], 0
    ds_read_b128 a[172:175], v209 offset:19456
    s_add_u32 s36, s34, 12288
    s_waitcnt lgkmcnt(6)
    v_mfma_f32_16x16x32_bf16 v[16:19], a[148:151], v[124:127], v[16:19]
    buffer_load_dwordx4 v218, s[8:11], s37 offen offset:2048 nt lds
    s_waitcnt lgkmcnt(5)
    v_mfma_f32_16x16x32_bf16 v[16:19], a[152:155], v[128:131], v[16:19]
    s_add_u32 s37, s32, 589824
    s_waitcnt lgkmcnt(4)
    v_mfma_f32_16x16x32_bf16 v[16:19], a[156:159], v[132:135], v[16:19]
    ds_read_b128 a[176:179], v209 offset:20480
    s_mov_b32 m0, s36
    s_waitcnt lgkmcnt(4)
    v_mfma_f32_16x16x32_bf16 v[16:19], a[160:163], v[136:139], v[16:19]
    ds_read_b128 a[180:183], v209 offset:21504
    s_add_u32 s36, s34, 18432
    s_waitcnt lgkmcnt(4)
    v_mfma_f32_16x16x32_bf16 v[16:19], a[164:167], v[140:143], v[16:19]
    buffer_load_dwordx4 v216, s[8:11], s37 offen offset:0 nt lds
    v_mfma_f32_16x16x32_bf16 v[20:23], a[144:147], v[144:147], 0
    v_mfma_f32_16x16x32_bf16 v[20:23], a[148:151], v[148:151], v[20:23]
    ds_read_b128 a[184:187], v209 offset:22528
    ds_read_b128 a[188:191], v209 offset:23552
    v_mfma_f32_16x16x32_bf16 v[20:23], a[152:155], v[152:155], v[20:23]
    v_cvt_pk_bf16_f32 v112, v0, v1
    v_mfma_f32_16x16x32_bf16 v[20:23], a[156:159], v[156:159], v[20:23]
    buffer_load_dwordx4 v217, s[8:11], s37 offen offset:1024 nt lds
    v_mfma_f32_16x16x32_bf16 v[20:23], a[160:163], v[160:163], v[20:23]
    v_cvt_pk_bf16_f32 v113, v2, v3
    v_mfma_f32_16x16x32_bf16 v[20:23], a[164:167], v[164:167], v[20:23]
    v_cvt_pk_bf16_f32 v114, v8, v9
    s_waitcnt lgkmcnt(5)
    v_mfma_f32_16x16x32_bf16 v[24:27], a[168:171], v[120:123], 0
    v_cvt_pk_bf16_f32 v115, v10, v11
    s_waitcnt lgkmcnt(4)
    v_mfma_f32_16x16x32_bf16 v[24:27], a[172:175], v[124:127], v[24:27]
    buffer_load_dwordx4 v218, s[8:11], s37 offen offset:2048 nt lds
    s_waitcnt lgkmcnt(3)
    v_mfma_f32_16x16x32_bf16 v[24:27], a[176:179], v[128:131], v[24:27]
    s_add_u32 s37, s32, 884736
    s_mov_b32 m0, s36
    s_waitcnt lgkmcnt(2)
    v_mfma_f32_16x16x32_bf16 v[24:27], a[180:183], v[132:135], v[24:27]
    v_cvt_pk_bf16_f32 v116, v4, v5
    s_waitcnt lgkmcnt(1)
    v_mfma_f32_16x16x32_bf16 v[24:27], a[184:187], v[136:139], v[24:27]
    buffer_load_dwordx4 v216, s[8:11], s37 offen offset:0 nt lds
    s_waitcnt lgkmcnt(0)
    v_mfma_f32_16x16x32_bf16 v[24:27], a[188:191], v[140:143], v[24:27]
    v_cvt_pk_bf16_f32 v117, v6, v7
    v_mfma_f32_16x16x32_bf16 v[28:31], a[168:171], v[144:147], 0
    v_cvt_pk_bf16_f32 v118, v12, v13
    v_mfma_f32_16x16x32_bf16 v[28:31], a[172:175], v[148:151], v[28:31]
    buffer_load_dwordx4 v217, s[8:11], s37 offen offset:1024 nt lds
    v_mfma_f32_16x16x32_bf16 v[28:31], a[176:179], v[152:155], v[28:31]
    v_cvt_pk_bf16_f32 v119, v14, v15
    v_mfma_f32_16x16x32_bf16 v[28:31], a[180:183], v[156:159], v[28:31]
    ds_read_b128 v[176:179], v193 offset:128
    v_mfma_f32_16x16x32_bf16 v[28:31], a[184:187], v[160:163], v[28:31]
    buffer_load_dwordx4 v218, s[8:11], s37 offen offset:2048 nt lds
    v_mfma_f32_16x16x32_bf16 v[28:31], a[188:191], v[164:167], v[28:31]
    ds_read_b128 v[180:183], v193 offset:6272
    v_mfma_f32_16x16x32_bf16 v[32:35], v[128:131], v[112:115], v[32:35]
    v_mfma_f32_16x16x32_bf16 v[48:51], v[168:171], v[112:115], v[48:51]
    s_add_u32 s35, s35, 1
    s_add_u32 s34, s34, 24576
    s_cmp_eq_u32 s35, 5
    s_cselect_b32 s35, 0, s35
    s_cselect_b32 s29, 122880, 0
    s_sub_u32 s34, s34, s29
    v_mfma_f32_16x16x32_bf16 v[40:43], v[128:131], v[116:119], v[40:43]
    v_mfma_f32_16x16x32_bf16 v[56:59], v[168:171], v[116:119], v[56:59]
    ds_read_b128 v[168:171], v192 offset:256
    v_mfma_f32_16x16x32_bf16 v[36:39], v[152:155], v[112:115], v[36:39]
    v_mfma_f32_16x16x32_bf16 v[52:55], v[172:175], v[112:115], v[52:55]
    v_mfma_f32_16x16x32_bf16 v[44:47], v[152:155], v[116:119], v[44:47]
    v_mfma_f32_16x16x32_bf16 v[60:63], v[172:175], v[116:119], v[60:63]
    ds_read_b128 v[172:175], v192 offset:6400
    s_waitcnt vmcnt(24)
    s_waitcnt lgkmcnt(0)
    s_barrier
    ds_read_b128 a[192:195], v209 offset:24576
    ds_read_b128 a[196:199], v209 offset:25600
    v_cvt_pk_bf16_f32 v96, v16, v17
    v_cvt_pk_bf16_f32 v97, v18, v19
    v_cvt_pk_bf16_f32 v98, v24, v25
    v_cvt_pk_bf16_f32 v99, v26, v27
    v_cvt_pk_bf16_f32 v100, v20, v21
    v_cvt_pk_bf16_f32 v101, v22, v23
    v_mfma_f32_16x16x32_bf16 v[32:35], v[132:135], v[96:99], v[32:35]
    v_cvt_pk_bf16_f32 v102, v28, v29
    v_cvt_pk_bf16_f32 v103, v30, v31
    v_mfma_f32_16x16x32_bf16 v[48:51], v[176:179], v[96:99], v[48:51]
    ds_read_b128 a[200:203], v209 offset:26624
    v_mfma_f32_16x16x32_bf16 v[40:43], v[132:135], v[100:103], v[40:43]
    ds_read_b128 a[204:207], v209 offset:27648
    v_mfma_f32_16x16x32_bf16 v[56:59], v[176:179], v[100:103], v[56:59]
    ds_read_b128 a[208:211], v209 offset:28672
    v_mfma_f32_16x16x32_bf16 v[36:39], v[156:159], v[96:99], v[36:39]
    ds_read_b128 a[212:215], v209 offset:29696
    v_mfma_f32_16x16x32_bf16 v[52:55], v[180:183], v[96:99], v[52:55]
    v_mfma_f32_16x16x32_bf16 v[44:47], v[156:159], v[100:103], v[44:47]
    v_mfma_f32_16x16x32_bf16 v[60:63], v[180:183], v[100:103], v[60:63]
    s_waitcnt lgkmcnt(5)
    v_mfma_f32_16x16x32_bf16 v[0:3], a[192:195], v[120:123], 0
    s_waitcnt lgkmcnt(4)
    v_mfma_f32_16x16x32_bf16 v[0:3], a[196:199], v[124:127], v[0:3]
    s_waitcnt lgkmcnt(3)
    v_mfma_f32_16x16x32_bf16 v[0:3], a[200:203], v[128:131], v[0:3]
    s_waitcnt lgkmcnt(2)
    v_mfma_f32_16x16x32_bf16 v[0:3], a[204:207], v[132:135], v[0:3]
    ds_read_b128 a[216:219], v209 offset:30720
    s_waitcnt lgkmcnt(2)
    v_mfma_f32_16x16x32_bf16 v[0:3], a[208:211], v[136:139], v[0:3]
    ds_read_b128 a[220:223], v209 offset:31744
    s_waitcnt lgkmcnt(2)
    v_mfma_f32_16x16x32_bf16 v[0:3], a[212:215], v[140:143], v[0:3]
    ds_read_b128 a[224:227], v209 offset:32768
    v_mfma_f32_16x16x32_bf16 v[4:7], a[192:195], v[144:147], 0
    ds_read_b128 a[228:231], v209 offset:33792
    v_mfma_f32_16x16x32_bf16 v[4:7], a[196:199], v[148:151], v[4:7]
    ds_read_b128 a[232:235], v209 offset:34816
    v_mfma_f32_16x16x32_bf16 v[4:7], a[200:203], v[152:155], v[4:7]
    ds_read_b128 a[236:239], v209 offset:35840
    v_mfma_f32_16x16x32_bf16 v[4:7], a[204:207], v[156:159], v[4:7]
    v_mfma_f32_16x16x32_bf16 v[4:7], a[208:211], v[160:163], v[4:7]
    v_mfma_f32_16x16x32_bf16 v[4:7], a[212:215], v[164:167], v[4:7]
    s_waitcnt lgkmcnt(5)
    v_mfma_f32_16x16x32_bf16 v[8:11], a[216:219], v[120:123], 0
    s_waitcnt lgkmcnt(4)
    v_mfma_f32_16x16x32_bf16 v[8:11], a[220:223], v[124:127], v[8:11]
    s_waitcnt lgkmcnt(3)
    v_mfma_f32_16x16x32_bf16 v[8:11], a[224:227], v[128:131], v[8:11]
    s_waitcnt lgkmcnt(2)
    v_mfma_f32_16x16x32_bf16 v[8:11], a[228:231], v[132:135], v[8:11]
    ds_read_b128 a[240:243], v209 offset:36864
    s_waitcnt lgkmcnt(2)
    v_mfma_f32_16x16x32_bf16 v[8:11], a[232:235], v[136:139], v[8:11]
    ds_read_b128 a[244:247], v209 offset:37888
    s_waitcnt lgkmcnt(2)
    v_mfma_f32_16x16x32_bf16 v[8:11], a[236:239], v[140:143], v[8:11]
    ds_read_b128 a[248:251], v209 offset:38912
    v_mfma_f32_16x16x32_bf16 v[12:15], a[216:219], v[144:147], 0
    ds_read_b128 a[252:255], v209 offset:39936
    v_mfma_f32_16x16x32_bf16 v[12:15], a[220:223], v[148:151], v[12:15]
    ds_read_b128 v[224:227], v209 offset:40960
    v_mfma_f32_16x16x32_bf16 v[12:15], a[224:227], v[152:155], v[12:15]
    ds_read_b128 v[228:231], v209 offset:41984
    v_mfma_f32_16x16x32_bf16 v[12:15], a[228:231], v[156:159], v[12:15]
    v_mfma_f32_16x16x32_bf16 v[12:15], a[232:235], v[160:163], v[12:15]
    v_mfma_f32_16x16x32_bf16 v[12:15], a[236:239], v[164:167], v[12:15]
    s_waitcnt lgkmcnt(5)
    v_mfma_f32_16x16x32_bf16 v[16:19], a[240:243], v[120:123], 0
    s_waitcnt lgkmcnt(4)
    v_mfma_f32_16x16x32_bf16 v[16:19], a[244:247], v[124:127], v[16:19]
    s_waitcnt lgkmcnt(3)
    v_mfma_f32_16x16x32_bf16 v[16:19], a[248:251], v[128:131], v[16:19]
    s_waitcnt lgkmcnt(2)
    v_mfma_f32_16x16x32_bf16 v[16:19], a[252:255], v[132:135], v[16:19]
    ds_read_b128 v[232:235], v209 offset:43008
    s_waitcnt lgkmcnt(2)
    v_mfma_f32_16x16x32_bf16 v[16:19], v[224:227], v[136:139], v[16:19]
    ds_read_b128 v[236:239], v209 offset:44032
    s_waitcnt lgkmcnt(2)
    v_mfma_f32_16x16x32_bf16 v[16:19], v[228:231], v[140:143], v[16:19]
    ds_read_b128 v[240:243], v209 offset:45056
    v_mfma_f32_16x16x32_bf16 v[20:23], a[240:243], v[144:147], 0
    ds_read_b128 v[244:247], v209 offset:46080
    v_mfma_f32_16x16x32_bf16 v[20:23], a[244:247], v[148:151], v[20:23]
    ds_read_b128 v[248:251], v209 offset:47104
    v_mfma_f32_16x16x32_bf16 v[20:23], a[248:251], v[152:155], v[20:23]
    ds_read_b128 v[252:255], v209 offset:48128
    v_mfma_f32_16x16x32_bf16 v[20:23], a[252:255], v[156:159], v[20:23]
    v_mfma_f32_16x16x32_bf16 v[20:23], v[224:227], v[160:163], v[20:23]
    v_mfma_f32_16x16x32_bf16 v[20:23], v[228:231], v[164:167], v[20:23]
    s_waitcnt lgkmcnt(5)
    v_mfma_f32_16x16x32_bf16 v[24:27], v[232:235], v[120:123], 0
    v_cvt_pk_bf16_f32 v104, v0, v1
    s_waitcnt lgkmcnt(4)
    v_mfma_f32_16x16x32_bf16 v[24:27], v[236:239], v[124:127], v[24:27]
    v_cvt_pk_bf16_f32 v105, v2, v3
    s_waitcnt lgkmcnt(3)
    v_mfma_f32_16x16x32_bf16 v[24:27], v[240:243], v[128:131], v[24:27]
    v_cvt_pk_bf16_f32 v106, v8, v9
    s_waitcnt lgkmcnt(2)
    v_mfma_f32_16x16x32_bf16 v[24:27], v[244:247], v[132:135], v[24:27]
    s_waitcnt lgkmcnt(1)
    v_mfma_f32_16x16x32_bf16 v[24:27], v[248:251], v[136:139], v[24:27]
    v_cvt_pk_bf16_f32 v107, v10, v11
    s_waitcnt lgkmcnt(0)
    v_mfma_f32_16x16x32_bf16 v[24:27], v[252:255], v[140:143], v[24:27]
    v_cvt_pk_bf16_f32 v108, v4, v5
    v_mfma_f32_16x16x32_bf16 v[28:31], v[232:235], v[144:147], 0
    v_cvt_pk_bf16_f32 v109, v6, v7
    v_mfma_f32_16x16x32_bf16 v[28:31], v[236:239], v[148:151], v[28:31]
    v_mfma_f32_16x16x32_bf16 v[28:31], v[240:243], v[152:155], v[28:31]
    v_cvt_pk_bf16_f32 v110, v12, v13
    v_mfma_f32_16x16x32_bf16 v[28:31], v[244:247], v[156:159], v[28:31]
    v_cvt_pk_bf16_f32 v111, v14, v15
    v_mfma_f32_16x16x32_bf16 v[28:31], v[248:251], v[160:163], v[28:31]
    v_mfma_f32_16x16x32_bf16 v[28:31], v[252:255], v[164:167], v[28:31]
    ds_read_b128 v[176:179], v193 offset:256
    v_mfma_f32_16x16x32_bf16 v[32:35], v[136:139], v[104:107], v[32:35]
    v_add_u32 v192, s26, v192
    v_mfma_f32_16x16x32_bf16 v[48:51], v[168:171], v[104:107], v[48:51]
    ds_read_b128 v[180:183], v193 offset:6400
    v_mfma_f32_16x16x32_bf16 v[40:43], v[136:139], v[108:111], v[40:43]
    v_mfma_f32_16x16x32_bf16 v[56:59], v[168:171], v[108:111], v[56:59]
    v_add_u32 v193, s26, v193
    v_mfma_f32_16x16x32_bf16 v[36:39], v[160:163], v[104:107], v[36:39]
    v_mfma_f32_16x16x32_bf16 v[52:55], v[172:175], v[104:107], v[52:55]
    v_mfma_f32_16x16x32_bf16 v[44:47], v[160:163], v[108:111], v[44:47]
    v_mfma_f32_16x16x32_bf16 v[60:63], v[172:175], v[108:111], v[60:63]
    s_waitcnt vmcnt(0)
    s_waitcnt lgkmcnt(0)
    s_barrier
    s_mov_b32 s21, 1
    ds_read_b128 v[120:123], v194 offset:0
    ds_read_b128 v[144:147], v194 offset:6144
    ds_read_b128 v[124:127], v195 offset:0
    ds_read_b128 v[148:151], v195 offset:6144
    ds_read_b128 v[128:131], v194 offset:128
    ds_read_b128 v[152:155], v194 offset:6272
    ds_read_b128 v[132:135], v195 offset:128
    ds_read_b128 v[156:159], v195 offset:6272
    ds_read_b128 v[136:139], v194 offset:256
    ds_read_b128 v[160:163], v194 offset:6400
    ds_read_b128 v[140:143], v195 offset:256
    ds_read_b128 v[164:167], v195 offset:6400
L_s_loop:
    v_cvt_pk_bf16_f32 v112, v16, v17
    s_waitcnt lgkmcnt(11)
    v_mfma_f32_16x16x32_bf16 v[0:3], a[0:3], v[120:123], 0
    v_cvt_pk_bf16_f32 v113, v18, v19
    v_cvt_pk_bf16_f32 v114, v24, v25
    s_waitcnt lgkmcnt(10)
    v_mfma_f32_16x16x32_bf16 v[0:3], a[4:7], v[124:127], v[0:3]
    v_cvt_pk_bf16_f32 v115, v26, v27
    s_waitcnt lgkmcnt(9)
    v_mfma_f32_16x16x32_bf16 v[0:3], a[8:11], v[128:131], v[0:3]
    v_cvt_pk_bf16_f32 v116, v20, v21
    v_cvt_pk_bf16_f32 v117, v22, v23
    s_waitcnt lgkmcnt(8)
    v_mfma_f32_16x16x32_bf16 v[0:3], a[12:15], v[132:135], v[0:3]
    v_cvt_pk_bf16_f32 v118, v28, v29
    s_waitcnt lgkmcnt(1)
    v_mfma_f32_16x16x32_bf16 v[0:3], a[16:19], v[136:139], v[0:3]
    v_cvt_pk_bf16_f32 v119, v30, v31
    ds_read_b128 v[168:171], v192 offset:0
    v_mfma_f32_16x16x32_bf16 v[0:3], a[20:23], v[140:143], v[0:3]
    ds_read_b128 v[172:175], v192 offset:6144
    v_mfma_f32_16x16x32_bf16 v[32:35], v[184:187], v[112:115], v[32:35]
    s_add_u32 s23, s23, 1
    s_cmp_eq_u32 s23, 5
    s_cselect_b32 s26, 4294868992, s39
    s_cselect_b32 s23, 0, s23
    v_mfma_f32_16x16x32_bf16 v[48:51], v[176:179], v[112:115], v[48:51]
    v_add_u32 v194, s26, v194
    v_mfma_f32_16x16x32_bf16 v[40:43], v[184:187], v[116:119], v[40:43]
    ds_read_b128 v[184:187], v195 offset:256
    v_mfma_f32_16x16x32_bf16 v[56:59], v[176:179], v[116:119], v[56:59]
    ds_read_b128 v[176:179], v193 offset:0
    v_cvt_pk_bf16_f32 v96, v0, v1
    v_mfma_f32_16x16x32_bf16 v[36:39], v[188:191], v[112:115], v[36:39]
    v_max3_f32 v198, v32, v33, v34
    v_mfma_f32_16x16x32_bf16 v[52:55], v[180:183], v[112:115], v[52:55]
    v_cvt_pk_bf16_f32 v97, v2, v3
    v_mfma_f32_16x16x32_bf16 v[44:47], v[188:191], v[116:119], v[44:47]
    ds_read_b128 v[188:191], v195 offset:6400
    v_add_u32 v195, s26, v195
    v_mfma_f32_16x16x32_bf16 v[60:63], v[180:183], v[116:119], v[60:63]
    ds_read_b128 v[180:183], v193 offset:6144
    v_mfma_f32_16x16x32_bf16 v[4:7], a[0:3], v[144:147], 0
    v_max3_f32 v199, v40, v41, v42
    v_max3_f32 v198, v198, v35, v36
    v_mfma_f32_16x16x32_bf16 v[4:7], a[4:7], v[148:151], v[4:7]
    v_max3_f32 v198, v198, v37, v38
    v_mfma_f32_16x16x32_bf16 v[4:7], a[8:11], v[152:155], v[4:7]
    v_max3_f32 v198, v198, v39, v48
    v_max3_f32 v198, v198, v49, v50
    v_mfma_f32_16x16x32_bf16 v[4:7], a[12:15], v[156:159], v[4:7]
    v_max3_f32 v198, v198, v51, v52
    s_waitcnt lgkmcnt(6)
    v_mfma_f32_16x16x32_bf16 v[4:7], a[16:19], v[160:163], v[4:7]
    v_max3_f32 v198, v198, v53, v54
    v_max_f32 v198, v198, v55
    v_mfma_f32_16x16x32_bf16 v[4:7], a[20:23], v[164:167], v[4:7]
    v_mov_b32 v200, v198
    v_mfma_f32_16x16x32_bf16 v[8:11], a[24:27], v[120:123], 0
    s_nop 0
    v_permlane16_swap_b32 v198, v200
    v_max_f32 v198, v198, v200
    v_mfma_f32_16x16x32_bf16 v[8:11], a[28:31], v[124:127], v[8:11]
    v_mov_b32 v200, v198
    v_mfma_f32_16x16x32_bf16 v[8:11], a[32:35], v[128:131], v[8:11]
    s_nop 0
    v_permlane32_swap_b32 v198, v200
    v_max_f32 v198, v198, v200
    v_mfma_f32_16x16x32_bf16 v[8:11], a[36:39], v[132:135], v[8:11]
    v_mul_f32 v202, s28, v198
    v_mfma_f32_16x16x32_bf16 v[8:11], a[40:43], v[136:139], v[8:11]
    v_fma_f32 v64, v32, s27, v202
    v_fma_f32 v65, v33, s27, v202
    v_mfma_f32_16x16x32_bf16 v[8:11], a[44:47], v[140:143], v[8:11]
    v_fma_f32 v66, v34, s27, v202
    v_mfma_f32_16x16x32_bf16 v[12:15], a[24:27], v[144:147], 0
    v_fma_f32 v67, v35, s27, v202
    v_fma_f32 v68, v36, s27, v202
    v_mfma_f32_16x16x32_bf16 v[12:15], a[28:31], v[148:151], v[12:15]
    v_fma_f32 v69, v37, s27, v202
    v_mfma_f32_16x16x32_bf16 v[12:15], a[32:35], v[152:155], v[12:15]
    v_fma_f32 v70, v38, s27, v202
    v_fma_f32 v71, v39, s27, v202
    v_mfma_f32_16x16x32_bf16 v[12:15], a[36:39], v[156:159], v[12:15]
    v_cvt_pk_bf16_f32 v100, v4, v5
    v_mfma_f32_16x16x32_bf16 v[12:15], a[40:43], v[160:163], v[12:15]
    v_cvt_pk_bf16_f32 v101, v6, v7
    v_fma_f32 v80, v48, s27, v202
    v_mfma_f32_16x16x32_bf16 v[12:15], a[44:47], v[164:167], v[12:15]
    v_fma_f32 v81, v49, s27, v202
    v_mfma_f32_16x16x32_bf16 v[16:19], a[48:51], v[120:123], 0
    v_fma_f32 v82, v50, s27, v202
    v_fma_f32 v83, v51, s27, v202
    v_mfma_f32_16x16x32_bf16 v[16:19], a[52:55], v[124:127], v[16:19]
    v_fma_f32 v84, v52, s27, v202
    v_mfma_f32_16x16x32_bf16 v[16:19], a[56:59], v[128:131], v[16:19]
    v_fma_f32 v85, v53, s27, v202
    v_fma_f32 v86, v54, s27, v202
    v_mfma_f32_16x16x32_bf16 v[16:19], a[60:63], v[132:135], v[16:19]
    v_fma_f32 v87, v55, s27, v202
    v_mfma_f32_16x16x32_bf16 v[16:19], a[64:67], v[136:139], v[16:19]
    v_exp_f32 v64, v64
    v_mfma_f32_16x16x32_bf16 v[16:19], a[68:71], v[140:143], v[16:19]
    v_cvt_pk_bf16_f32 v98, v8, v9
    v_mfma_f32_16x16x32_bf16 v[20:23], a[48:51], v[144:147], 0
    v_cvt_pk_bf16_f32 v99, v10, v11
    v_max3_f32 v199, v199, v43, v44
    v_mfma_f32_16x16x32_bf16 v[20:23], a[52:55], v[148:151], v[20:23]
    v_max3_f32 v199, v199, v45, v46
    v_mfma_f32_16x16x32_bf16 v[20:23], a[56:59], v[152:155], v[20:23]
    v_exp_f32 v65, v65
    v_mfma_f32_16x16x32_bf16 v[20:23], a[60:63], v[156:159], v[20:23]
    v_max3_f32 v199, v199, v47, v56
    v_mfma_f32_16x16x32_bf16 v[20:23], a[64:67], v[160:163], v[20:23]
    v_max3_f32 v199, v199, v57, v58
    v_max3_f32 v199, v199, v59, v60
    v_mfma_f32_16x16x32_bf16 v[20:23], a[68:71], v[164:167], v[20:23]
    v_max3_f32 v199, v199, v61, v62
    v_mfma_f32_16x16x32_bf16 v[24:27], a[72:75], v[120:123], 0
    v_max_f32 v199, v199, v63
    v_mov_b32 v201, v199
    v_mfma_f32_16x16x32_bf16 v[24:27], a[76:79], v[124:127], v[24:27]
    v_cvt_pk_bf16_f32 v102, v12, v13
    v_mfma_f32_16x16x32_bf16 v[24:27], a[80:83], v[128:131], v[24:27]
    v_cvt_pk_bf16_f32 v103, v14, v15
    v_permlane16_swap_b32 v199, v201
    v_mfma_f32_16x16x32_bf16 v[24:27], a[84:87], v[132:135], v[24:27]
    v_max_f32 v199, v199, v201
    v_mfma_f32_16x16x32_bf16 v[24:27], a[88:91], v[136:139], v[24:27]
    v_mov_b32 v201, v199
    s_nop 1
    v_permlane32_swap_b32 v199, v201
    v_mfma_f32_16x16x32_bf16 v[24:27], a[92:95], v[140:143], v[24:27]
    v_max_f32 v199, v199, v201
    v_mfma_f32_16x16x32_bf16 v[28:31], a[72:75], v[144:147], 0
    v_mul_f32 v203, s28, v199
    v_fma_f32 v72, v40, s27, v203
    v_mfma_f32_16x16x32_bf16 v[28:31], a[76:79], v[148:151], v[28:31]
    v_fma_f32 v73, v41, s27, v203
    v_mfma_f32_16x16x32_bf16 v[28:31], a[80:83], v[152:155], v[28:31]
    v_fma_f32 v74, v42, s27, v203
    v_fma_f32 v75, v43, s27, v203
    v_mfma_f32_16x16x32_bf16 v[28:31], a[84:87], v[156:159], v[28:31]
    v_fma_f32 v76, v44, s27, v203
    v_mfma_f32_16x16x32_bf16 v[28:31], a[88:91], v[160:163], v[28:31]
    v_fma_f32 v77, v45, s27, v203
    v_fma_f32 v78, v46, s27, v203
    v_mfma_f32_16x16x32_bf16 v[28:31], a[92:95], v[164:167], v[28:31]
    v_fma_f32 v79, v47, s27, v203
    v_mfma_f32_16x16x32_bf16 v[0:3], a[96:99], v[120:123], 0
    v_fma_f32 v88, v56, s27, v203
    v_fma_f32 v89, v57, s27, v203
    v_mfma_f32_16x16x32_bf16 v[0:3], a[100:103], v[124:127], v[0:3]
    v_fma_f32 v90, v58, s27, v203
    v_mfma_f32_16x16x32_bf16 v[0:3], a[104:107], v[128:131], v[0:3]
    v_fma_f32 v91, v59, s27, v203
    v_fma_f32 v92, v60, s27, v203
    v_mfma_f32_16x16x32_bf16 v[0:3], a[108:111], v[132:135], v[0:3]
    v_fma_f32 v93, v61, s27, v203
    v_mfma_f32_16x16x32_bf16 v[0:3], a[112:115], v[136:139], v[0:3]
    v_fma_f32 v94, v62, s27, v203
    v_fma_f32 v95, v63, s27, v203
    v_mfma_f32_16x16x32_bf16 v[0:3], a[116:119], v[140:143], v[0:3]
    v_cvt_pk_bf16_f32 v104, v16, v17
    v_mfma_f32_16x16x32_bf16 v[4:7], a[96:99], v[144:147], 0
    v_cvt_pk_bf16_f32 v105, v18, v19
    v_cvt_pk_bf16_f32 v106, v24, v25
    v_mfma_f32_16x16x32_bf16 v[4:7], a[100:103], v[148:151], v[4:7]
    v_cvt_pk_bf16_f32 v107, v26, v27
    v_mfma_f32_16x16x32_bf16 v[4:7], a[104:107], v[152:155], v[4:7]
    v_cvt_pk_bf16_f32 v108, v20, v21
    v_cvt_pk_bf16_f32 v109, v22, v23
    v_mfma_f32_16x16x32_bf16 v[4:7], a[108:111], v[156:159], v[4:7]
    v_cvt_pk_bf16_f32 v110, v28, v29
    v_mfma_f32_16x16x32_bf16 v[4:7], a[112:115], v[160:163], v[4:7]
    v_cvt_pk_bf16_f32 v111, v30, v31
    v_add_f32 v204, v64, v65
    v_mfma_f32_16x16x32_bf16 v[4:7], a[116:119], v[164:167], v[4:7]
    v_cvt_pk_bf16_f32 v112, v0, v1
    v_mfma_f32_16x16x32_bf16 v[8:11], a[120:123], v[120:123], 0
    v_exp_f32 v66, v66
    v_mfma_f32_16x16x32_bf16 v[8:11], a[124:127], v[124:127], v[8:11]
    v_cvt_pk_bf16_f32 v113, v2, v3
    v_mfma_f32_16x16x32_bf16 v[8:11], a[128:131], v[128:131], v[8:11]
    v_exp_f32 v67, v67
    v_mfma_f32_16x16x32_bf16 v[8:11], a[132:135], v[132:135], v[8:11]
    v_add_f32 v205, v66, v67
    v_mfma_f32_16x16x32_bf16 v[8:11], a[136:139], v[136:139], v[8:11]
    v_exp_f32 v68, v68
    v_mfma_f32_16x16x32_bf16 v[8:11], a[140:143], v[140:143], v[8:11]
    v_add_f32 v204, v204, v68
    v_mfma_f32_16x16x32_bf16 v[12:15], a[120:123], v[144:147], 0
    v_exp_f32 v69, v69
    v_mfma_f32_16x16x32_bf16 v[12:15], a[124:127], v[148:151], v[12:15]
    v_add_f32 v205, v205, v69
    v_mfma_f32_16x16x32_bf16 v[12:15], a[128:131], v[152:155], v[12:15]
    v_exp_f32 v70, v70
    v_mfma_f32_16x16x32_bf16 v[12:15], a[132:135], v[156:159], v[12:15]
    v_add_f32 v204, v204, v70
    v_mfma_f32_16x16x32_bf16 v[12:15], a[136:139], v[160:163], v[12:15]
    v_exp_f32 v71, v71
    v_mfma_f32_16x16x32_bf16 v[12:15], a[140:143], v[164:167], v[12:15]
    v_add_f32 v205, v205, v71
    v_mfma_f32_16x16x32_bf16 v[32:35], v[120:123], v[96:99], 0
    v_exp_f32 v80, v80
    s_waitcnt lgkmcnt(5)
    v_mfma_f32_16x16x32_bf16 v[48:51], v[168:171], v[96:99], 0
    v_add_f32 v204, v204, v80
    v_mfma_f32_16x16x32_bf16 v[40:43], v[120:123], v[100:103], 0
    v_exp_f32 v81, v81
    v_mfma_f32_16x16x32_bf16 v[56:59], v[168:171], v[100:103], 0
    v_add_f32 v205, v205, v81
    v_mfma_f32_16x16x32_bf16 v[36:39], v[144:147], v[96:99], 0
    v_exp_f32 v82, v82
    s_waitcnt lgkmcnt(4)
    v_mfma_f32_16x16x32_bf16 v[52:55], v[172:175], v[96:99], 0
    v_add_f32 v204, v204, v82
    v_mfma_f32_16x16x32_bf16 v[44:47], v[144:147], v[100:103], 0
    v_exp_f32 v83, v83
    v_mfma_f32_16x16x32_bf16 v[60:63], v[172:175], v[100:103], 0
    v_add_f32 v205, v205, v83
    v_mfma_f32_16x16x32_bf16 v[32:35], v[124:127], v[104:107], v[32:35]
    v_exp_f32 v84, v84
    s_waitcnt lgkmcnt(2)
    v_mfma_f32_16x16x32_bf16 v[48:51], v[176:179], v[104:107], v[48:51]
    v_add_f32 v204, v204, v84
    v_mfma_f32_16x16x32_bf16 v[40:43], v[124:127], v[108:111], v[40:43]
    v_exp_f32 v85, v85
    v_mfma_f32_16x16x32_bf16 v[56:59], v[176:179], v[108:111], v[56:59]
    v_add_f32 v205, v205, v85
    v_mfma_f32_16x16x32_bf16 v[36:39], v[148:151], v[104:107], v[36:39]
    v_exp_f32 v86, v86
    s_waitcnt lgkmcnt(0)
    v_mfma_f32_16x16x32_bf16 v[52:55], v[180:183], v[104:107], v[52:55]
    v_add_f32 v204, v204, v86
    v_mfma_f32_16x16x32_bf16 v[44:47], v[148:151], v[108:111], v[44:47]
    v_exp_f32 v87, v87
    v_mfma_f32_16x16x32_bf16 v[60:63], v[180:183], v[108:111], v[60:63]
    v_add_f32 v205, v205, v87
    v_mfma_f32_16x16x32_bf16 v[16:19], a[144:147], v[120:123], 0
    v_add_f32 v204, v204, v205
    v_mov_b32 v200, v204
    v_mfma_f32_16x16x32_bf16 v[16:19], a[148:151], v[124:127], v[16:19]
    s_nop 0
    v_permlane16_swap_b32 v204, v200
    v_mfma_f32_16x16x32_bf16 v[16:19], a[152:155], v[128:131], v[16:19]
    v_add_f32 v204, v204, v200
    v_mov_b32 v200, v204
    v_mfma_f32_16x16x32_bf16 v[16:19], a[156:159], v[132:135], v[16:19]
    ds_read_b128 v[168:171], v192 offset:128
    v_mfma_f32_16x16x32_bf16 v[16:19], a[160:163], v[136:139], v[16:19]
    v_permlane32_swap_b32 v204, v200
    v_add_f32 v204, v204, v200
    v_mfma_f32_16x16x32_bf16 v[16:19], a[164:167], v[140:143], v[16:19]
    ds_read_b128 v[172:175], v192 offset:6272
    v_mfma_f32_16x16x32_bf16 v[20:23], a[144:147], v[144:147], 0
    v_rcp_f32 v202, v204
    v_mfma_f32_16x16x32_bf16 v[20:23], a[148:151], v[148:151], v[20:23]
    v_mul_f32 v64, v64, v202
    v_mfma_f32_16x16x32_bf16 v[20:23], a[152:155], v[152:155], v[20:23]
    v_mul_f32 v65, v65, v202
    v_mul_f32 v66, v66, v202
    v_mfma_f32_16x16x32_bf16 v[20:23], a[156:159], v[156:159], v[20:23]
    v_cvt_pk_bf16_f32 v114, v8, v9
    v_mfma_f32_16x16x32_bf16 v[20:23], a[160:163], v[160:163], v[20:23]
    v_cvt_pk_bf16_f32 v115, v10, v11
    v_cvt_pk_bf16_f32 v116, v4, v5
    v_mfma_f32_16x16x32_bf16 v[20:23], a[164:167], v[164:167], v[20:23]
    v_cvt_pk_bf16_f32 v117, v6, v7
    v_mfma_f32_16x16x32_bf16 v[24:27], a[168:171], v[120:123], 0
    v_cvt_pk_bf16_f32 v118, v12, v13
    v_cvt_pk_bf16_f32 v119, v14, v15
    v_mfma_f32_16x16x32_bf16 v[24:27], a[172:175], v[124:127], v[24:27]
    v_mul_f32 v67, v67, v202
    v_mfma_f32_16x16x32_bf16 v[24:27], a[176:179], v[128:131], v[24:27]
    v_mul_f32 v68, v68, v202
    v_mul_f32 v69, v69, v202
    v_mfma_f32_16x16x32_bf16 v[24:27], a[180:183], v[132:135], v[24:27]
    v_mul_f32 v70, v70, v202
    v_mfma_f32_16x16x32_bf16 v[24:27], a[184:187], v[136:139], v[24:27]
    v_mul_f32 v71, v71, v202
    v_cvt_pk_bf16_f32 v64, v64, v65
    v_mfma_f32_16x16x32_bf16 v[24:27], a[188:191], v[140:143], v[24:27]
    v_cvt_pk_bf16_f32 v65, v66, v67
    v_mfma_f32_16x16x32_bf16 v[28:31], a[168:171], v[144:147], 0
    v_cvt_pk_bf16_f32 v66, v68, v69
    v_cvt_pk_bf16_f32 v67, v70, v71
    v_mfma_f32_16x16x32_bf16 v[28:31], a[172:175], v[148:151], v[28:31]
    ds_write_b128 v196, v[64:67] offset:0
    v_mfma_f32_16x16x32_bf16 v[28:31], a[176:179], v[152:155], v[28:31]
    v_mul_f32 v80, v80, v202
    v_mul_f32 v81, v81, v202
    v_mfma_f32_16x16x32_bf16 v[28:31], a[180:183], v[156:159], v[28:31]
    v_mul_f32 v82, v82, v202
    v_mfma_f32_16x16x32_bf16 v[28:31], a[184:187], v[160:163], v[28:31]
    v_mul_f32 v83, v83, v202
    v_mul_f32 v84, v84, v202
    v_mfma_f32_16x16x32_bf16 v[28:31], a[188:191], v[164:167], v[28:31]
    v_mul_f32 v85, v85, v202
    v_mfma_f32_16x16x32_bf16 v[32:35], v[128:131], v[112:115], v[32:35]
    v_mul_f32 v86, v86, v202
    v_mul_f32 v87, v87, v202
    s_waitcnt lgkmcnt(2)
    v_mfma_f32_16x16x32_bf16 v[48:51], v[168:171], v[112:115], v[48:51]
    v_cvt_pk_bf16_f32 v80, v80, v81
    v_mfma_f32_16x16x32_bf16 v[40:43], v[128:131], v[116:119], v[40:43]
    v_cvt_pk_bf16_f32 v81, v82, v83
    v_cvt_pk_bf16_f32 v82, v84, v85
    v_mfma_f32_16x16x32_bf16 v[56:59], v[168:171], v[116:119], v[56:59]
    ds_read_b128 v[176:179], v193 offset:128
    v_mfma_f32_16x16x32_bf16 v[36:39], v[152:155], v[112:115], v[36:39]
    v_exp_f32 v72, v72
    s_waitcnt lgkmcnt(2)
    v_mfma_f32_16x16x32_bf16 v[52:55], v[172:175], v[112:115], v[52:55]
    v_cvt_pk_bf16_f32 v83, v86, v87
    v_mfma_f32_16x16x32_bf16 v[44:47], v[152:155], v[116:119], v[44:47]
    v_exp_f32 v73, v73
    v_mfma_f32_16x16x32_bf16 v[60:63], v[172:175], v[116:119], v[60:63]
    ds_read_b128 v[180:183], v193 offset:6272
    v_mfma_f32_16x16x32_bf16 v[0:3], a[192:195], v[120:123], 0
    v_exp_f32 v74, v74
    v_mfma_f32_16x16x32_bf16 v[0:3], a[196:199], v[124:127], v[0:3]
    v_cvt_pk_bf16_f32 v96, v16, v17
    v_mfma_f32_16x16x32_bf16 v[0:3], a[200:203], v[128:131], v[0:3]
    v_exp_f32 v75, v75
    v_mfma_f32_16x16x32_bf16 v[0:3], a[204:207], v[132:135], v[0:3]
    v_cvt_pk_bf16_f32 v97, v18, v19
    v_mfma_f32_16x16x32_bf16 v[0:3], a[208:211], v[136:139], v[0:3]
    v_exp_f32 v76, v76
    v_mfma_f32_16x16x32_bf16 v[0:3], a[212:215], v[140:143], v[0:3]
    v_cvt_pk_bf16_f32 v98, v24, v25
    v_mfma_f32_16x16x32_bf16 v[4:7], a[192:195], v[144:147], 0
    v_exp_f32 v77, v77
    v_mfma_f32_16x16x32_bf16 v[4:7], a[196:199], v[148:151], v[4:7]
    v_cvt_pk_bf16_f32 v99, v26, v27
    v_mfma_f32_16x16x32_bf16 v[4:7], a[200:203], v[152:155], v[4:7]
    v_exp_f32 v78, v78
    v_mfma_f32_16x16x32_bf16 v[4:7], a[204:207], v[156:159], v[4:7]
    v_cvt_pk_bf16_f32 v100, v20, v21
    v_mfma_f32_16x16x32_bf16 v[4:7], a[208:211], v[160:163], v[4:7]
    v_exp_f32 v79, v79
    v_mfma_f32_16x16x32_bf16 v[4:7], a[212:215], v[164:167], v[4:7]
    v_exp_f32 v88, v88
    v_mfma_f32_16x16x32_bf16 v[8:11], a[216:219], v[120:123], 0
    v_exp_f32 v89, v89
    v_mfma_f32_16x16x32_bf16 v[8:11], a[220:223], v[124:127], v[8:11]
    v_exp_f32 v90, v90
    v_mfma_f32_16x16x32_bf16 v[8:11], a[224:227], v[128:131], v[8:11]
    v_exp_f32 v91, v91
    v_mfma_f32_16x16x32_bf16 v[8:11], a[228:231], v[132:135], v[8:11]
    v_exp_f32 v92, v92
    v_mfma_f32_16x16x32_bf16 v[8:11], a[232:235], v[136:139], v[8:11]
    v_mfma_f32_16x16x32_bf16 v[8:11], a[236:239], v[140:143], v[8:11]
    v_exp_f32 v93, v93
    v_mfma_f32_16x16x32_bf16 v[12:15], a[216:219], v[144:147], 0
    v_exp_f32 v94, v94
    v_mfma_f32_16x16x32_bf16 v[12:15], a[220:223], v[148:151], v[12:15]
    v_exp_f32 v95, v95
    v_mfma_f32_16x16x32_bf16 v[12:15], a[224:227], v[152:155], v[12:15]
    v_cvt_pk_bf16_f32 v101, v22, v23
    v_mfma_f32_16x16x32_bf16 v[12:15], a[228:231], v[156:159], v[12:15]
    v_cvt_pk_bf16_f32 v102, v28, v29
    v_mfma_f32_16x16x32_bf16 v[12:15], a[232:235], v[160:163], v[12:15]
    v_cvt_pk_bf16_f32 v103, v30, v31
    ds_write_b128 v197, v[80:83] offset:0
    v_mfma_f32_16x16x32_bf16 v[12:15], a[236:239], v[164:167], v[12:15]
    v_add_f32 v206, v72, v73
    v_mfma_f32_16x16x32_bf16 v[32:35], v[132:135], v[96:99], v[32:35]
    v_add_f32 v207, v74, v75
    v_add_f32 v206, v206, v76
    s_waitcnt lgkmcnt(2)
    v_mfma_f32_16x16x32_bf16 v[48:51], v[176:179], v[96:99], v[48:51]
    v_add_f32 v207, v207, v77
    v_mfma_f32_16x16x32_bf16 v[40:43], v[132:135], v[100:103], v[40:43]
    v_add_f32 v206, v206, v78
    v_add_f32 v207, v207, v79
    v_mfma_f32_16x16x32_bf16 v[56:59], v[176:179], v[100:103], v[56:59]
    v_add_f32 v206, v206, v88
    v_mfma_f32_16x16x32_bf16 v[36:39], v[156:159], v[96:99], v[36:39]
    v_add_f32 v207, v207, v89
    v_add_f32 v206, v206, v90
    s_waitcnt lgkmcnt(1)
    v_mfma_f32_16x16x32_bf16 v[52:55], v[180:183], v[96:99], v[52:55]
    v_add_f32 v207, v207, v91
    v_mfma_f32_16x16x32_bf16 v[44:47], v[156:159], v[100:103], v[44:47]
    v_add_f32 v206, v206, v92
    v_add_f32 v207, v207, v93
    v_mfma_f32_16x16x32_bf16 v[60:63], v[180:183], v[100:103], v[60:63]
    v_add_f32 v206, v206, v94
    v_mfma_f32_16x16x32_bf16 v[16:19], a[240:243], v[120:123], 0
    v_add_f32 v207, v207, v95
    v_add_f32 v206, v206, v207
    v_mfma_f32_16x16x32_bf16 v[16:19], a[244:247], v[124:127], v[16:19]
    v_mov_b32 v201, v206
    s_nop 1
    v_permlane16_swap_b32 v206, v201
    v_mfma_f32_16x16x32_bf16 v[16:19], a[248:251], v[128:131], v[16:19]
    v_add_f32 v206, v206, v201
    v_mov_b32 v201, v206
    v_mfma_f32_16x16x32_bf16 v[16:19], a[252:255], v[132:135], v[16:19]
    s_nop 0
    v_permlane32_swap_b32 v206, v201
    v_add_f32 v206, v206, v201
    v_mfma_f32_16x16x32_bf16 v[16:19], v[224:227], v[136:139], v[16:19]
    v_rcp_f32 v203, v206
    v_mfma_f32_16x16x32_bf16 v[16:19], v[228:231], v[140:143], v[16:19]
    v_mul_f32 v72, v72, v203
    v_mul_f32 v73, v73, v203
    v_mfma_f32_16x16x32_bf16 v[20:23], a[240:243], v[144:147], 0
    v_mul_f32 v74, v74, v203
    v_mul_f32 v75, v75, v203
    v_mfma_f32_16x16x32_bf16 v[20:23], a[244:247], v[148:151], v[20:23]
    v_mul_f32 v76, v76, v203
    v_mul_f32 v77, v77, v203
    v_mfma_f32_16x16x32_bf16 v[20:23], a[248:251], v[152:155], v[20:23]
    v_mul_f32 v78, v78, v203
    v_mul_f32 v79, v79, v203
    v_mfma_f32_16x16x32_bf16 v[20:23], a[252:255], v[156:159], v[20:23]
    v_cvt_pk_bf16_f32 v72, v72, v73
    v_cvt_pk_bf16_f32 v73, v74, v75
    v_mfma_f32_16x16x32_bf16 v[20:23], v[224:227], v[160:163], v[20:23]
    v_cvt_pk_bf16_f32 v74, v76, v77
    v_cvt_pk_bf16_f32 v75, v78, v79
    v_mfma_f32_16x16x32_bf16 v[20:23], v[228:231], v[164:167], v[20:23]
    ds_write_b128 v196, v[72:75] offset:2048
    v_mul_f32 v88, v88, v203
    v_mfma_f32_16x16x32_bf16 v[24:27], v[232:235], v[120:123], 0
    v_mul_f32 v89, v89, v203
    v_mul_f32 v90, v90, v203
    v_mfma_f32_16x16x32_bf16 v[24:27], v[236:239], v[124:127], v[24:27]
    v_mul_f32 v91, v91, v203
    v_mul_f32 v92, v92, v203
    v_mfma_f32_16x16x32_bf16 v[24:27], v[240:243], v[128:131], v[24:27]
    v_mul_f32 v93, v93, v203
    v_mul_f32 v94, v94, v203
    v_mfma_f32_16x16x32_bf16 v[24:27], v[244:247], v[132:135], v[24:27]
    v_mul_f32 v95, v95, v203
    v_cvt_pk_bf16_f32 v88, v88, v89
    v_mfma_f32_16x16x32_bf16 v[24:27], v[248:251], v[136:139], v[24:27]
    v_cvt_pk_bf16_f32 v89, v90, v91
    ds_read_b128 v[168:171], v192 offset:256
    v_mfma_f32_16x16x32_bf16 v[24:27], v[252:255], v[140:143], v[24:27]
    v_cvt_pk_bf16_f32 v90, v92, v93
    v_cvt_pk_bf16_f32 v91, v94, v95
    v_mfma_f32_16x16x32_bf16 v[28:31], v[232:235], v[144:147], 0
    ds_write_b128 v197, v[88:91] offset:2048
    v_xor_b32 v196, 0x2000, v196
    v_mfma_f32_16x16x32_bf16 v[28:31], v[236:239], v[148:151], v[28:31]
    v_xor_b32 v197, 0x2000, v197
    ds_read_b128 v[172:175], v192 offset:6400
    v_mfma_f32_16x16x32_bf16 v[28:31], v[240:243], v[152:155], v[28:31]
    v_cvt_pk_bf16_f32 v104, v0, v1
    v_add_u32 v192, s26, v192
    v_mfma_f32_16x16x32_bf16 v[28:31], v[244:247], v[156:159], v[28:31]
    v_cvt_pk_bf16_f32 v105, v2, v3
    v_cvt_pk_bf16_f32 v108, v4, v5
    v_mfma_f32_16x16x32_bf16 v[28:31], v[248:251], v[160:163], v[28:31]
    v_cvt_pk_bf16_f32 v106, v8, v9
    v_cvt_pk_bf16_f32 v107, v10, v11
    v_mfma_f32_16x16x32_bf16 v[28:31], v[252:255], v[164:167], v[28:31]
    ds_read_b128 v[176:179], v193 offset:256
    v_cvt_pk_bf16_f32 v109, v6, v7
    v_mfma_f32_16x16x32_bf16 v[32:35], v[136:139], v[104:107], v[32:35]
    v_cvt_pk_bf16_f32 v110, v12, v13
    v_cvt_pk_bf16_f32 v111, v14, v15
    s_waitcnt lgkmcnt(3)
    v_mfma_f32_16x16x32_bf16 v[48:51], v[168:171], v[104:107], v[48:51]
    ds_read_b128 v[180:183], v193 offset:6400
    v_add_u32 v193, s26, v193
    v_mfma_f32_16x16x32_bf16 v[40:43], v[136:139], v[108:111], v[40:43]
    ds_read_b128 v[120:123], v194 offset:0
    ds_read_b128 v[124:127], v195 offset:0
    v_mfma_f32_16x16x32_bf16 v[56:59], v[168:171], v[108:111], v[56:59]
    ds_read_b128 v[128:131], v194 offset:128
    ds_read_b128 v[132:135], v195 offset:128
    v_mfma_f32_16x16x32_bf16 v[36:39], v[160:163], v[104:107], v[36:39]
    ds_read_b128 v[144:147], v194 offset:6144
    ds_read_b128 v[140:143], v195 offset:256
    s_waitcnt lgkmcnt(8)
    v_mfma_f32_16x16x32_bf16 v[52:55], v[172:175], v[104:107], v[52:55]
    ds_read_b128 v[148:151], v195 offset:6144
    ds_read_b128 v[152:155], v194 offset:6272
    v_mfma_f32_16x16x32_bf16 v[44:47], v[160:163], v[108:111], v[44:47]
    ds_read_b128 v[156:159], v195 offset:6272
    ds_read_b128 v[164:167], v195 offset:6400
    v_mfma_f32_16x16x32_bf16 v[60:63], v[172:175], v[108:111], v[60:63]
    ds_read_b128 v[136:139], v194 offset:256
    ds_read_b128 v[160:163], v194 offset:6400
    s_waitcnt lgkmcnt(12)
    s_barrier
    s_add_u32 s21, s21, 1
    s_cmp_lt_u32 s21, 9
    s_cbranch_scc1 L_s_loop
    v_cvt_pk_bf16_f32 v112, v16, v17
    v_cvt_pk_bf16_f32 v113, v18, v19
    v_cvt_pk_bf16_f32 v114, v24, v25
    v_cvt_pk_bf16_f32 v115, v26, v27
    v_cvt_pk_bf16_f32 v116, v20, v21
    v_cvt_pk_bf16_f32 v117, v22, v23
    v_cvt_pk_bf16_f32 v118, v28, v29
    v_cvt_pk_bf16_f32 v119, v30, v31
    v_mfma_f32_16x16x32_bf16 v[32:35], v[184:187], v[112:115], v[32:35]
    v_mfma_f32_16x16x32_bf16 v[48:51], v[176:179], v[112:115], v[48:51]
    v_mfma_f32_16x16x32_bf16 v[40:43], v[184:187], v[116:119], v[40:43]
    v_mfma_f32_16x16x32_bf16 v[56:59], v[176:179], v[116:119], v[56:59]
    v_mfma_f32_16x16x32_bf16 v[36:39], v[188:191], v[112:115], v[36:39]
    v_mfma_f32_16x16x32_bf16 v[52:55], v[180:183], v[112:115], v[52:55]
    v_mfma_f32_16x16x32_bf16 v[44:47], v[188:191], v[116:119], v[44:47]
    v_mfma_f32_16x16x32_bf16 v[60:63], v[180:183], v[116:119], v[60:63]
    s_nop 0
    v_max3_f32 v198, v32, v33, v34
    s_nop 0
    v_max3_f32 v199, v40, v41, v42
    s_nop 0
    v_max3_f32 v198, v198, v35, v36
    s_nop 0
    v_max3_f32 v199, v199, v43, v44
    v_max3_f32 v198, v198, v37, v38
    v_max3_f32 v199, v199, v45, v46
    v_max3_f32 v198, v198, v39, v48
    v_max3_f32 v199, v199, v47, v56
    v_max3_f32 v198, v198, v49, v50
    v_max3_f32 v199, v199, v57, v58
    v_max3_f32 v198, v198, v51, v52
    v_max3_f32 v199, v199, v59, v60
    v_max3_f32 v198, v198, v53, v54
    v_max3_f32 v199, v199, v61, v62
    v_max_f32 v198, v198, v55
    v_max_f32 v199, v199, v63
    v_mov_b32 v200, v198
    v_mov_b32 v201, v199
    s_nop 0
    v_permlane16_swap_b32 v198, v200
    v_permlane16_swap_b32 v199, v201
    v_max_f32 v198, v198, v200
    v_max_f32 v199, v199, v201
    v_mov_b32 v200, v198
    v_mov_b32 v201, v199
    s_nop 0
    v_permlane32_swap_b32 v198, v200
    v_permlane32_swap_b32 v199, v201
    v_max_f32 v198, v198, v200
    v_max_f32 v199, v199, v201
    v_mul_f32 v202, s28, v198
    v_mul_f32 v203, s28, v199
    v_fma_f32 v64, v32, s27, v202
    v_fma_f32 v72, v40, s27, v203
    v_fma_f32 v65, v33, s27, v202
    v_fma_f32 v73, v41, s27, v203
    v_fma_f32 v66, v34, s27, v202
    v_fma_f32 v74, v42, s27, v203
    v_fma_f32 v67, v35, s27, v202
    v_fma_f32 v75, v43, s27, v203
    v_fma_f32 v68, v36, s27, v202
    v_fma_f32 v76, v44, s27, v203
    v_fma_f32 v69, v37, s27, v202
    v_fma_f32 v77, v45, s27, v203
    v_fma_f32 v70, v38, s27, v202
    v_fma_f32 v78, v46, s27, v203
    v_fma_f32 v71, v39, s27, v202
    v_fma_f32 v79, v47, s27, v203
    v_fma_f32 v80, v48, s27, v202
    v_fma_f32 v88, v56, s27, v203
    v_fma_f32 v81, v49, s27, v202
    v_fma_f32 v89, v57, s27, v203
    v_fma_f32 v82, v50, s27, v202
    v_fma_f32 v90, v58, s27, v203
    v_fma_f32 v83, v51, s27, v202
    v_fma_f32 v91, v59, s27, v203
    v_fma_f32 v84, v52, s27, v202
    v_fma_f32 v92, v60, s27, v203
    v_fma_f32 v85, v53, s27, v202
    v_fma_f32 v93, v61, s27, v203
    v_fma_f32 v86, v54, s27, v202
    v_fma_f32 v94, v62, s27, v203
    v_fma_f32 v87, v55, s27, v202
    v_fma_f32 v95, v63, s27, v203
    v_exp_f32 v64, v64
    v_exp_f32 v72, v72
    v_exp_f32 v65, v65
    v_exp_f32 v73, v73
    v_exp_f32 v66, v66
    v_exp_f32 v74, v74
    v_exp_f32 v67, v67
    v_exp_f32 v75, v75
    v_exp_f32 v68, v68
    v_exp_f32 v76, v76
    v_exp_f32 v69, v69
    v_exp_f32 v77, v77
    v_exp_f32 v70, v70
    v_exp_f32 v78, v78
    v_exp_f32 v71, v71
    v_exp_f32 v79, v79
    v_exp_f32 v80, v80
    v_exp_f32 v88, v88
    v_exp_f32 v81, v81
    v_exp_f32 v89, v89
    v_exp_f32 v82, v82
    v_exp_f32 v90, v90
    v_exp_f32 v83, v83
    v_exp_f32 v91, v91
    v_exp_f32 v84, v84
    v_exp_f32 v92, v92
    v_exp_f32 v85, v85
    v_exp_f32 v93, v93
    v_exp_f32 v86, v86
    v_exp_f32 v94, v94
    v_exp_f32 v87, v87
    v_exp_f32 v95, v95
    v_add_f32 v204, v64, v65
    v_add_f32 v206, v72, v73
    v_add_f32 v205, v66, v67
    v_add_f32 v207, v74, v75
    v_add_f32 v204, v204, v68
    v_add_f32 v206, v206, v76
    v_add_f32 v205, v205, v69
    v_add_f32 v207, v207, v77
    v_add_f32 v204, v204, v70
    v_add_f32 v206, v206, v78
    v_add_f32 v205, v205, v71
    v_add_f32 v207, v207, v79
    v_add_f32 v204, v204, v80
    v_add_f32 v206, v206, v88
    v_add_f32 v205, v205, v81
    v_add_f32 v207, v207, v89
    v_add_f32 v204, v204, v82
    v_add_f32 v206, v206, v90
    v_add_f32 v205, v205, v83
    v_add_f32 v207, v207, v91
    v_add_f32 v204, v204, v84
    v_add_f32 v206, v206, v92
    v_add_f32 v205, v205, v85
    v_add_f32 v207, v207, v93
    v_add_f32 v204, v204, v86
    v_add_f32 v206, v206, v94
    v_add_f32 v205, v205, v87
    v_add_f32 v207, v207, v95
    v_add_f32 v204, v204, v205
    v_add_f32 v206, v206, v207
    v_mov_b32 v200, v204
    v_mov_b32 v201, v206
    s_nop 0
    v_permlane16_swap_b32 v204, v200
    v_permlane16_swap_b32 v206, v201
    v_add_f32 v204, v204, v200
    v_add_f32 v206, v206, v201
    v_mov_b32 v200, v204
    v_mov_b32 v201, v206
    s_nop 0
    v_permlane32_swap_b32 v204, v200
    v_permlane32_swap_b32 v206, v201
    v_add_f32 v204, v204, v200
    v_add_f32 v206, v206, v201
    v_rcp_f32 v202, v204
    v_rcp_f32 v203, v206
    v_mul_f32 v64, v64, v202
    v_mul_f32 v72, v72, v203
    v_mul_f32 v65, v65, v202
    v_mul_f32 v73, v73, v203
    v_mul_f32 v66, v66, v202
    v_mul_f32 v74, v74, v203
    v_mul_f32 v67, v67, v202
    v_mul_f32 v75, v75, v203
    v_mul_f32 v68, v68, v202
    v_mul_f32 v76, v76, v203
    v_mul_f32 v69, v69, v202
    v_mul_f32 v77, v77, v203
    v_mul_f32 v70, v70, v202
    v_mul_f32 v78, v78, v203
    v_mul_f32 v71, v71, v202
    v_mul_f32 v79, v79, v203
    v_cvt_pk_bf16_f32 v64, v64, v65
    v_cvt_pk_bf16_f32 v72, v72, v73
    v_cvt_pk_bf16_f32 v65, v66, v67
    v_cvt_pk_bf16_f32 v73, v74, v75
    v_cvt_pk_bf16_f32 v66, v68, v69
    v_cvt_pk_bf16_f32 v74, v76, v77
    v_cvt_pk_bf16_f32 v67, v70, v71
    v_cvt_pk_bf16_f32 v75, v78, v79
    ds_write_b128 v196, v[64:67] offset:0
    ds_write_b128 v196, v[72:75] offset:2048
    v_mul_f32 v80, v80, v202
    v_mul_f32 v88, v88, v203
    v_mul_f32 v81, v81, v202
    v_mul_f32 v89, v89, v203
    v_mul_f32 v82, v82, v202
    v_mul_f32 v90, v90, v203
    v_mul_f32 v83, v83, v202
    v_mul_f32 v91, v91, v203
    v_mul_f32 v84, v84, v202
    v_mul_f32 v92, v92, v203
    v_mul_f32 v85, v85, v202
    v_mul_f32 v93, v93, v203
    v_mul_f32 v86, v86, v202
    v_mul_f32 v94, v94, v203
    v_mul_f32 v87, v87, v202
    v_mul_f32 v95, v95, v203
    v_cvt_pk_bf16_f32 v80, v80, v81
    v_cvt_pk_bf16_f32 v88, v88, v89
    v_cvt_pk_bf16_f32 v81, v82, v83
    v_cvt_pk_bf16_f32 v89, v90, v91
    v_cvt_pk_bf16_f32 v82, v84, v85
    v_cvt_pk_bf16_f32 v90, v92, v93
    v_cvt_pk_bf16_f32 v83, v86, v87
    v_cvt_pk_bf16_f32 v91, v94, v95
    ds_write_b128 v197, v[80:83] offset:0
    ds_write_b128 v197, v[88:91] offset:2048
    s_waitcnt lgkmcnt(0)
    s_barrier
    s_endpgm
L_owave:
    s_sub_u32 s20, s20, 2
    v_lshlrev_b32 v255, 4, v250
    s_lshl_b32 s29, s20, 2
    v_add_u32 v244, 0, v250
    v_mul_u32_u24 v244, 2731, v244
    v_lshrrev_b32 v244, 17, v244
    v_or_b32 v244, s29, v244
    v_xor_b32 v244, v244, v250
    v_lshlrev_b32 v227, 4, v244
    v_add_u32 v244, 64, v250
    v_mul_u32_u24 v244, 2731, v244
    v_lshrrev_b32 v244, 17, v244
    v_or_b32 v244, s29, v244
    v_xor_b32 v244, v244, v250
    v_lshlrev_b32 v228, 4, v244
    v_add_u32 v244, 128, v250
    v_mul_u32_u24 v244, 2731, v244
    v_lshrrev_b32 v244, 17, v244
    v_or_b32 v244, s29, v244
    v_xor_b32 v244, v244, v250
    v_lshlrev_b32 v229, 4, v244
    s_mul_i32 s38, s20, 147456
    s_mul_i32 s34, s20, 3072
    s_add_u32 s34, s34, 40960
    s_mov_b32 s35, 0
    s_add_u32 s31, s22, 0
    s_mul_hi_u32 s29, s31, 89478486
    s_mul_i32 s30, s29, 48
    s_sub_u32 s30, s31, s30
    s_mul_i32 s29, s29, 1179648
    s_mul_i32 s30, s30, 3072
    s_add_u32 s32, s29, s30
    s_add_u32 s32, s32, s38
    s_add_u32 s36, s34, 0
    s_add_u32 s37, s32, 0
    s_mov_b32 m0, s36
    s_nop 0
    buffer_load_dwordx4 v227, s[8:11], s37 offen offset:0 nt lds
    buffer_load_dwordx4 v228, s[8:11], s37 offen offset:1024 nt lds
    buffer_load_dwordx4 v229, s[8:11], s37 offen offset:2048 nt lds
    s_add_u32 s36, s34, 6144
    s_add_u32 s37, s32, 294912
    s_mov_b32 m0, s36
    s_nop 0
    buffer_load_dwordx4 v227, s[8:11], s37 offen offset:0 nt lds
    buffer_load_dwordx4 v228, s[8:11], s37 offen offset:1024 nt lds
    buffer_load_dwordx4 v229, s[8:11], s37 offen offset:2048 nt lds
    s_add_u32 s36, s34, 12288
    s_add_u32 s37, s32, 589824
    s_mov_b32 m0, s36
    s_nop 0
    buffer_load_dwordx4 v227, s[8:11], s37 offen offset:0 nt lds
    buffer_load_dwordx4 v228, s[8:11], s37 offen offset:1024 nt lds
    buffer_load_dwordx4 v229, s[8:11], s37 offen offset:2048 nt lds
    s_add_u32 s36, s34, 18432
    s_add_u32 s37, s32, 884736
    s_mov_b32 m0, s36
    s_nop 0
    buffer_load_dwordx4 v227, s[8:11], s37 offen offset:0 nt lds
    buffer_load_dwordx4 v228, s[8:11], s37 offen offset:1024 nt lds
    buffer_load_dwordx4 v229, s[8:11], s37 offen offset:2048 nt lds
    s_add_u32 s35, s35, 1
    s_add_u32 s34, s34, 24576
    s_cmp_eq_u32 s35, 5
    s_cselect_b32 s35, 0, s35
    s_cselect_b32 s29, 122880, 0
    s_sub_u32 s34, s34, s29
    s_mul_i32 s51, s20, 36864
    s_add_u32 s51, s51, 73728
    s_lshl_b32 s50, s20, 10
    s_add_u32 s36, s50, 114688
    s_add_u32 s37, s50, 24576
    s_mov_b32 m0, s36
    s_nop 0
    buffer_load_dwordx4 v255, s[16:19], s37 offen offset:0 lds
    s_add_u32 s36, s50, 116736
    s_add_u32 s37, s50, 26624
    s_mov_b32 m0, s36
    s_nop 0
    buffer_load_dwordx4 v255, s[16:19], s37 offen offset:0 lds
    s_add_u32 s36, s50, 118784
    s_add_u32 s37, s50, 28672
    s_mov_b32 m0, s36
    s_nop 0
    buffer_load_dwordx4 v255, s[16:19], s37 offen offset:0 lds
    s_add_u32 s36, s50, 120832
    s_add_u32 s37, s50, 30720
    s_mov_b32 m0, s36
    s_nop 0
    buffer_load_dwordx4 v255, s[16:19], s37 offen offset:0 lds
    s_add_u32 s36, s50, 122880
    s_add_u32 s37, s50, 32768
    s_mov_b32 m0, s36
    s_nop 0
    buffer_load_dwordx4 v255, s[16:19], s37 offen offset:0 lds
    s_add_u32 s36, s50, 124928
    s_add_u32 s37, s50, 34816
    s_mov_b32 m0, s36
    s_nop 0
    buffer_load_dwordx4 v255, s[16:19], s37 offen offset:0 lds
    s_add_u32 s36, s50, 126976
    s_add_u32 s37, s50, 36864
    s_mov_b32 m0, s36
    s_nop 0
    buffer_load_dwordx4 v255, s[16:19], s37 offen offset:0 lds
    s_add_u32 s36, s50, 129024
    s_add_u32 s37, s50, 38912
    s_mov_b32 m0, s36
    s_nop 0
    buffer_load_dwordx4 v255, s[16:19], s37 offen offset:0 lds
    s_add_u32 s36, s50, 131072
    s_add_u32 s37, s50, 40960
    s_mov_b32 m0, s36
    s_nop 0
    buffer_load_dwordx4 v255, s[16:19], s37 offen offset:0 lds
    s_add_u32 s36, s50, 133120
    s_add_u32 s37, s50, 43008
    s_mov_b32 m0, s36
    s_nop 0
    buffer_load_dwordx4 v255, s[16:19], s37 offen offset:0 lds
    s_add_u32 s36, s50, 135168
    s_add_u32 s37, s50, 45056
    s_mov_b32 m0, s36
    s_nop 0
    buffer_load_dwordx4 v255, s[16:19], s37 offen offset:0 lds
    s_add_u32 s36, s50, 137216
    s_add_u32 s37, s50, 47104
    s_mov_b32 m0, s36
    s_nop 0
    buffer_load_dwordx4 v255, s[16:19], s37 offen offset:0 lds
    v_mov_b32 v224, v246
    v_mov_b32 v225, v247
    v_mov_b32 v226, v255
    s_mul_i32 s30, s20, 12288
    s_add_u32 s30, s30, 16384
    v_and_b32 v244, 3, v253
    v_mul_u32_u24 v245, 192, v252
    v_add_u32 v245, s30, v245
    v_xor_b32 v254, v251, v244
    v_lshlrev_b32 v254, 4, v254
    v_add_u32 v233, v245, v254
    s_mov_b32 s31, 147456
    s_mul_i32 s29, s20, 192
    v_add_u32 v244, 0, v250
    v_mul_u32_u24 v245, 5462, v244
    v_lshrrev_b32 v245, 16, v245
    v_lshrrev_b32 v254, 1, v245
    v_and_b32 v254, 3, v254
    v_xor_b32 v254, v254, v244
    v_lshlrev_b32 v254, 4, v254
    v_add_u32 v234, s30, v254
    v_mul_u32_u24 v254, 12, v245
    v_sub_u32 v244, v244, v254
    v_lshlrev_b32 v244, 4, v244
    v_add_u32 v244, s29, v244
    v_and_b32 v254, 7, v245
    v_mul_u32_u24 v254, 384, v254
    v_add_u32 v244, v244, v254
    v_lshrrev_b32 v254, 3, v245
    v_mul_lo_u32 v254, v254, s31
    v_add_u32 v230, v244, v254
    v_add_u32 v244, 64, v250
    v_mul_u32_u24 v245, 5462, v244
    v_lshrrev_b32 v245, 16, v245
    v_lshrrev_b32 v254, 1, v245
    v_and_b32 v254, 3, v254
    v_xor_b32 v254, v254, v244
    v_lshlrev_b32 v254, 4, v254
    v_add_u32 v235, s30, v254
    v_mul_u32_u24 v254, 12, v245
    v_sub_u32 v244, v244, v254
    v_lshlrev_b32 v244, 4, v244
    v_add_u32 v244, s29, v244
    v_and_b32 v254, 7, v245
    v_mul_u32_u24 v254, 384, v254
    v_add_u32 v244, v244, v254
    v_lshrrev_b32 v254, 3, v245
    v_mul_lo_u32 v254, v254, s31
    v_add_u32 v231, v244, v254
    v_add_u32 v244, 128, v250
    v_mul_u32_u24 v245, 5462, v244
    v_lshrrev_b32 v245, 16, v245
    v_lshrrev_b32 v254, 1, v245
    v_and_b32 v254, 3, v254
    v_xor_b32 v254, v254, v244
    v_lshlrev_b32 v254, 4, v254
    v_add_u32 v236, s30, v254
    v_mul_u32_u24 v254, 12, v245
    v_sub_u32 v244, v244, v254
    v_lshlrev_b32 v244, 4, v244
    v_add_u32 v244, s29, v244
    v_and_b32 v254, 7, v245
    v_mul_u32_u24 v254, 384, v254
    v_add_u32 v244, v244, v254
    v_lshrrev_b32 v254, 3, v245
    v_mul_lo_u32 v254, v254, s31
    v_add_u32 v232, v244, v254
    s_waitcnt vmcnt(12)
    s_barrier
    s_add_u32 s49, s51, 0
    buffer_load_dwordx4 a[0:3], v255, s[16:19], s49 offen offset:0
    s_add_u32 s49, s51, 0
    buffer_load_dwordx4 a[4:7], v255, s[16:19], s49 offen offset:1024
    s_add_u32 s49, s51, 0
    buffer_load_dwordx4 a[8:11], v255, s[16:19], s49 offen offset:2048
    s_add_u32 s49, s51, 0
    buffer_load_dwordx4 a[12:15], v255, s[16:19], s49 offen offset:3072
    s_add_u32 s49, s51, 4096
    buffer_load_dwordx4 a[16:19], v255, s[16:19], s49 offen offset:0
    s_add_u32 s49, s51, 4096
    buffer_load_dwordx4 a[20:23], v255, s[16:19], s49 offen offset:1024
    s_add_u32 s49, s51, 4096
    buffer_load_dwordx4 a[24:27], v255, s[16:19], s49 offen offset:2048
    s_add_u32 s49, s51, 4096
    buffer_load_dwordx4 a[28:31], v255, s[16:19], s49 offen offset:3072
    s_add_u32 s49, s51, 8192
    buffer_load_dwordx4 a[32:35], v255, s[16:19], s49 offen offset:0
    s_add_u32 s49, s51, 8192
    buffer_load_dwordx4 a[36:39], v255, s[16:19], s49 offen offset:1024
    s_add_u32 s49, s51, 8192
    buffer_load_dwordx4 a[40:43], v255, s[16:19], s49 offen offset:2048
    s_add_u32 s49, s51, 8192
    buffer_load_dwordx4 a[44:47], v255, s[16:19], s49 offen offset:3072
    s_waitcnt vmcnt(12)
    s_barrier
    s_add_u32 s49, s51, 12288
    buffer_load_dwordx4 a[48:51], v255, s[16:19], s49 offen offset:0
    s_add_u32 s49, s51, 12288
    buffer_load_dwordx4 a[52:55], v255, s[16:19], s49 offen offset:1024
    s_add_u32 s49, s51, 12288
    buffer_load_dwordx4 a[56:59], v255, s[16:19], s49 offen offset:2048
    s_add_u32 s49, s51, 12288
    buffer_load_dwordx4 a[60:63], v255, s[16:19], s49 offen offset:3072
    s_add_u32 s49, s51, 16384
    buffer_load_dwordx4 a[64:67], v255, s[16:19], s49 offen offset:0
    s_add_u32 s49, s51, 16384
    buffer_load_dwordx4 a[68:71], v255, s[16:19], s49 offen offset:1024
    s_add_u32 s49, s51, 16384
    buffer_load_dwordx4 a[72:75], v255, s[16:19], s49 offen offset:2048
    s_add_u32 s49, s51, 16384
    buffer_load_dwordx4 a[76:79], v255, s[16:19], s49 offen offset:3072
    s_add_u32 s49, s51, 20480
    buffer_load_dwordx4 a[80:83], v255, s[16:19], s49 offen offset:0
    s_add_u32 s49, s51, 20480
    buffer_load_dwordx4 a[84:87], v255, s[16:19], s49 offen offset:1024
    s_add_u32 s49, s51, 20480
    buffer_load_dwordx4 a[88:91], v255, s[16:19], s49 offen offset:2048
    s_add_u32 s49, s51, 20480
    buffer_load_dwordx4 a[92:95], v255, s[16:19], s49 offen offset:3072
    s_add_u32 s49, s51, 24576
    buffer_load_dwordx4 a[96:99], v255, s[16:19], s49 offen offset:0
    s_add_u32 s49, s51, 24576
    buffer_load_dwordx4 a[100:103], v255, s[16:19], s49 offen offset:1024
    s_add_u32 s49, s51, 24576
    buffer_load_dwordx4 a[104:107], v255, s[16:19], s49 offen offset:2048
    s_add_u32 s49, s51, 24576
    buffer_load_dwordx4 a[108:111], v255, s[16:19], s49 offen offset:3072
    s_add_u32 s49, s51, 28672
    buffer_load_dwordx4 a[112:115], v255, s[16:19], s49 offen offset:0
    s_add_u32 s49, s51, 28672
    buffer_load_dwordx4 a[116:119], v255, s[16:19], s49 offen offset:1024
    s_add_u32 s49, s51, 28672
    buffer_load_dwordx4 a[120:123], v255, s[16:19], s49 offen offset:2048
    s_add_u32 s49, s51, 28672
    buffer_load_dwordx4 a[124:127], v255, s[16:19], s49 offen offset:3072
    s_add_u32 s49, s51, 32768
    buffer_load_dwordx4 a[128:131], v255, s[16:19], s49 offen offset:0
    s_add_u32 s49, s51, 32768
    buffer_load_dwordx4 a[132:135], v255, s[16:19], s49 offen offset:1024
    s_add_u32 s49, s51, 32768
    buffer_load_dwordx4 a[136:139], v255, s[16:19], s49 offen offset:2048
    s_add_u32 s49, s51, 32768
    buffer_load_dwordx4 a[140:143], v255, s[16:19], s49 offen offset:3072
    s_waitcnt vmcnt(24)
    ds_read_b128 a[144:147], v224 offset:0
    ds_read_b128 a[148:151], v225 offset:0
    ds_read_b128 a[152:155], v224 offset:128
    ds_read_b128 a[156:159], v225 offset:128
    ds_read_b128 a[160:163], v224 offset:256
    ds_read_b128 a[164:167], v225 offset:256
    s_waitcnt lgkmcnt(5)
    v_mfma_f32_16x16x32_bf16 v[0:3], a[144:147], a[0:3], 0
    s_waitcnt lgkmcnt(4)
    v_mfma_f32_16x16x32_bf16 v[0:3], a[148:151], a[4:7], v[0:3]
    s_waitcnt lgkmcnt(3)
    v_mfma_f32_16x16x32_bf16 v[0:3], a[152:155], a[8:11], v[0:3]
    s_waitcnt lgkmcnt(2)
    v_mfma_f32_16x16x32_bf16 v[0:3], a[156:159], a[12:15], v[0:3]
    ds_read_b128 a[168:171], v224 offset:6144
    s_waitcnt lgkmcnt(2)
    v_mfma_f32_16x16x32_bf16 v[0:3], a[160:163], a[16:19], v[0:3]
    ds_read_b128 a[172:175], v225 offset:6144
    s_waitcnt lgkmcnt(2)
    v_mfma_f32_16x16x32_bf16 v[0:3], a[164:167], a[20:23], v[0:3]
    ds_read_b128 a[176:179], v224 offset:6272
    v_mfma_f32_16x16x32_bf16 v[16:19], a[144:147], a[24:27], 0
    ds_read_b128 a[180:183], v225 offset:6272
    v_mfma_f32_16x16x32_bf16 v[16:19], a[148:151], a[28:31], v[16:19]
    ds_read_b128 a[184:187], v224 offset:6400
    v_mfma_f32_16x16x32_bf16 v[16:19], a[152:155], a[32:35], v[16:19]
    ds_read_b128 a[188:191], v225 offset:6400
    v_mfma_f32_16x16x32_bf16 v[16:19], a[156:159], a[36:39], v[16:19]
    v_mfma_f32_16x16x32_bf16 v[16:19], a[160:163], a[40:43], v[16:19]
    v_mfma_f32_16x16x32_bf16 v[16:19], a[164:167], a[44:47], v[16:19]
    s_waitcnt lgkmcnt(5)
    v_mfma_f32_16x16x32_bf16 v[4:7], a[168:171], a[0:3], 0
    s_waitcnt lgkmcnt(4)
    v_mfma_f32_16x16x32_bf16 v[4:7], a[172:175], a[4:7], v[4:7]
    s_waitcnt lgkmcnt(3)
    v_mfma_f32_16x16x32_bf16 v[4:7], a[176:179], a[8:11], v[4:7]
    s_waitcnt lgkmcnt(2)
    v_mfma_f32_16x16x32_bf16 v[4:7], a[180:183], a[12:15], v[4:7]
    ds_read_b128 a[144:147], v224 offset:12288
    s_waitcnt lgkmcnt(2)
    v_mfma_f32_16x16x32_bf16 v[4:7], a[184:187], a[16:19], v[4:7]
    ds_read_b128 a[148:151], v225 offset:12288
    s_waitcnt lgkmcnt(2)
    v_mfma_f32_16x16x32_bf16 v[4:7], a[188:191], a[20:23], v[4:7]
    ds_read_b128 a[152:155], v224 offset:12416
    v_mfma_f32_16x16x32_bf16 v[20:23], a[168:171], a[24:27], 0
    ds_read_b128 a[156:159], v225 offset:12416
    v_mfma_f32_16x16x32_bf16 v[20:23], a[172:175], a[28:31], v[20:23]
    ds_read_b128 a[160:163], v224 offset:12544
    v_mfma_f32_16x16x32_bf16 v[20:23], a[176:179], a[32:35], v[20:23]
    ds_read_b128 a[164:167], v225 offset:12544
    v_mfma_f32_16x16x32_bf16 v[20:23], a[180:183], a[36:39], v[20:23]
    v_mfma_f32_16x16x32_bf16 v[20:23], a[184:187], a[40:43], v[20:23]
    v_mfma_f32_16x16x32_bf16 v[20:23], a[188:191], a[44:47], v[20:23]
    s_waitcnt lgkmcnt(5)
    v_mfma_f32_16x16x32_bf16 v[8:11], a[144:147], a[0:3], 0
    s_waitcnt lgkmcnt(4)
    v_mfma_f32_16x16x32_bf16 v[8:11], a[148:151], a[4:7], v[8:11]
    s_waitcnt lgkmcnt(3)
    v_mfma_f32_16x16x32_bf16 v[8:11], a[152:155], a[8:11], v[8:11]
    s_waitcnt lgkmcnt(2)
    v_mfma_f32_16x16x32_bf16 v[8:11], a[156:159], a[12:15], v[8:11]
    ds_read_b128 a[168:171], v224 offset:18432
    s_waitcnt lgkmcnt(2)
    v_mfma_f32_16x16x32_bf16 v[8:11], a[160:163], a[16:19], v[8:11]
    ds_read_b128 a[172:175], v225 offset:18432
    s_waitcnt lgkmcnt(2)
    v_mfma_f32_16x16x32_bf16 v[8:11], a[164:167], a[20:23], v[8:11]
    ds_read_b128 a[176:179], v224 offset:18560
    v_mfma_f32_16x16x32_bf16 v[24:27], a[144:147], a[24:27], 0
    ds_read_b128 a[180:183], v225 offset:18560
    v_mfma_f32_16x16x32_bf16 v[24:27], a[148:151], a[28:31], v[24:27]
    ds_read_b128 a[184:187], v224 offset:18688
    v_mfma_f32_16x16x32_bf16 v[24:27], a[152:155], a[32:35], v[24:27]
    ds_read_b128 a[188:191], v225 offset:18688
    v_mfma_f32_16x16x32_bf16 v[24:27], a[156:159], a[36:39], v[24:27]
    v_mfma_f32_16x16x32_bf16 v[24:27], a[160:163], a[40:43], v[24:27]
    v_mfma_f32_16x16x32_bf16 v[24:27], a[164:167], a[44:47], v[24:27]
    s_waitcnt lgkmcnt(5)
    v_mfma_f32_16x16x32_bf16 v[12:15], a[168:171], a[0:3], 0
    s_waitcnt lgkmcnt(4)
    v_mfma_f32_16x16x32_bf16 v[12:15], a[172:175], a[4:7], v[12:15]
    s_waitcnt lgkmcnt(3)
    v_mfma_f32_16x16x32_bf16 v[12:15], a[176:179], a[8:11], v[12:15]
    s_waitcnt lgkmcnt(2)
    v_mfma_f32_16x16x32_bf16 v[12:15], a[180:183], a[12:15], v[12:15]
    s_waitcnt lgkmcnt(1)
    v_mfma_f32_16x16x32_bf16 v[12:15], a[184:187], a[16:19], v[12:15]
    s_waitcnt lgkmcnt(0)
    v_mfma_f32_16x16x32_bf16 v[12:15], a[188:191], a[20:23], v[12:15]
    v_mfma_f32_16x16x32_bf16 v[28:31], a[168:171], a[24:27], 0
    v_mfma_f32_16x16x32_bf16 v[28:31], a[172:175], a[28:31], v[28:31]
    v_mfma_f32_16x16x32_bf16 v[28:31], a[176:179], a[32:35], v[28:31]
    v_mfma_f32_16x16x32_bf16 v[28:31], a[180:183], a[36:39], v[28:31]
    v_mfma_f32_16x16x32_bf16 v[28:31], a[184:187], a[40:43], v[28:31]
    v_mfma_f32_16x16x32_bf16 v[28:31], a[188:191], a[44:47], v[28:31]
    s_barrier
    s_add_u32 s34, s34, 49152
    s_mov_b32 s35, 3
    s_waitcnt vmcnt(12)
    ds_read_b128 a[144:147], v224 offset:0
    ds_read_b128 a[148:151], v225 offset:0
    ds_read_b128 a[152:155], v224 offset:128
    ds_read_b128 a[156:159], v225 offset:128
    ds_read_b128 a[160:163], v224 offset:256
    ds_read_b128 a[164:167], v225 offset:256
    s_waitcnt lgkmcnt(5)
    v_mfma_f32_16x16x32_bf16 v[32:35], a[144:147], a[48:51], 0
    s_waitcnt lgkmcnt(4)
    v_mfma_f32_16x16x32_bf16 v[32:35], a[148:151], a[52:55], v[32:35]
    s_waitcnt lgkmcnt(3)
    v_mfma_f32_16x16x32_bf16 v[32:35], a[152:155], a[56:59], v[32:35]
    s_waitcnt lgkmcnt(2)
    v_mfma_f32_16x16x32_bf16 v[32:35], a[156:159], a[60:63], v[32:35]
    s_waitcnt lgkmcnt(1)
    v_mfma_f32_16x16x32_bf16 v[32:35], a[160:163], a[64:67], v[32:35]
    s_waitcnt lgkmcnt(0)
    v_mfma_f32_16x16x32_bf16 v[32:35], a[164:167], a[68:71], v[32:35]
    v_mfma_f32_16x16x32_bf16 v[48:51], a[144:147], a[72:75], 0
    v_mfma_f32_16x16x32_bf16 v[48:51], a[148:151], a[76:79], v[48:51]
    v_mfma_f32_16x16x32_bf16 v[48:51], a[152:155], a[80:83], v[48:51]
    v_mfma_f32_16x16x32_bf16 v[48:51], a[156:159], a[84:87], v[48:51]
    v_mfma_f32_16x16x32_bf16 v[48:51], a[160:163], a[88:91], v[48:51]
    s_waitcnt vmcnt(0)
    v_mfma_f32_16x16x32_bf16 v[48:51], a[164:167], a[92:95], v[48:51]
    v_mfma_f32_16x16x32_bf16 v[64:67], a[144:147], a[96:99], 0
    v_mfma_f32_16x16x32_bf16 v[64:67], a[148:151], a[100:103], v[64:67]
    v_mfma_f32_16x16x32_bf16 v[64:67], a[152:155], a[104:107], v[64:67]
    v_mfma_f32_16x16x32_bf16 v[64:67], a[156:159], a[108:111], v[64:67]
    ds_read_b128 a[168:171], v224 offset:6144
    v_mfma_f32_16x16x32_bf16 v[64:67], a[160:163], a[112:115], v[64:67]
    ds_read_b128 a[172:175], v225 offset:6144
    v_mfma_f32_16x16x32_bf16 v[64:67], a[164:167], a[116:119], v[64:67]
    ds_read_b128 a[176:179], v224 offset:6272
    v_mfma_f32_16x16x32_bf16 v[80:83], a[144:147], a[120:123], 0
    ds_read_b128 a[180:183], v225 offset:6272
    v_mfma_f32_16x16x32_bf16 v[80:83], a[148:151], a[124:127], v[80:83]
    ds_read_b128 a[184:187], v224 offset:6400
    v_mfma_f32_16x16x32_bf16 v[80:83], a[152:155], a[128:131], v[80:83]
    ds_read_b128 a[188:191], v225 offset:6400
    v_mfma_f32_16x16x32_bf16 v[80:83], a[156:159], a[132:135], v[80:83]
    v_mfma_f32_16x16x32_bf16 v[80:83], a[160:163], a[136:139], v[80:83]
    v_mfma_f32_16x16x32_bf16 v[80:83], a[164:167], a[140:143], v[80:83]
    s_waitcnt lgkmcnt(5)
    v_mfma_f32_16x16x32_bf16 v[36:39], a[168:171], a[48:51], 0
    s_waitcnt lgkmcnt(4)
    v_mfma_f32_16x16x32_bf16 v[36:39], a[172:175], a[52:55], v[36:39]
    s_waitcnt lgkmcnt(3)
    v_mfma_f32_16x16x32_bf16 v[36:39], a[176:179], a[56:59], v[36:39]
    s_waitcnt lgkmcnt(2)
    v_mfma_f32_16x16x32_bf16 v[36:39], a[180:183], a[60:63], v[36:39]
    s_waitcnt lgkmcnt(1)
    v_mfma_f32_16x16x32_bf16 v[36:39], a[184:187], a[64:67], v[36:39]
    s_waitcnt lgkmcnt(0)
    v_mfma_f32_16x16x32_bf16 v[36:39], a[188:191], a[68:71], v[36:39]
    v_mfma_f32_16x16x32_bf16 v[52:55], a[168:171], a[72:75], 0
    v_mfma_f32_16x16x32_bf16 v[52:55], a[172:175], a[76:79], v[52:55]
    v_mfma_f32_16x16x32_bf16 v[52:55], a[176:179], a[80:83], v[52:55]
    v_mfma_f32_16x16x32_bf16 v[52:55], a[180:183], a[84:87], v[52:55]
    v_mfma_f32_16x16x32_bf16 v[52:55], a[184:187], a[88:91], v[52:55]
    v_mfma_f32_16x16x32_bf16 v[52:55], a[188:191], a[92:95], v[52:55]
    v_mfma_f32_16x16x32_bf16 v[68:71], a[168:171], a[96:99], 0
    v_mfma_f32_16x16x32_bf16 v[68:71], a[172:175], a[100:103], v[68:71]
    v_mfma_f32_16x16x32_bf16 v[68:71], a[176:179], a[104:107], v[68:71]
    ds_read_b128 a[144:147], v224 offset:12288
    v_mfma_f32_16x16x32_bf16 v[68:71], a[180:183], a[108:111], v[68:71]
    v_mfma_f32_16x16x32_bf16 v[68:71], a[184:187], a[112:115], v[68:71]
    ds_read_b128 a[148:151], v225 offset:12288
    v_mfma_f32_16x16x32_bf16 v[68:71], a[188:191], a[116:119], v[68:71]
    ds_read_b128 a[152:155], v224 offset:12416
    v_mfma_f32_16x16x32_bf16 v[84:87], a[168:171], a[120:123], 0
    ds_read_b128 a[156:159], v225 offset:12416
    v_mfma_f32_16x16x32_bf16 v[84:87], a[172:175], a[124:127], v[84:87]
    ds_read_b128 a[160:163], v224 offset:12544
    v_mfma_f32_16x16x32_bf16 v[84:87], a[176:179], a[128:131], v[84:87]
    ds_read_b128 a[164:167], v225 offset:12544
    v_mfma_f32_16x16x32_bf16 v[84:87], a[180:183], a[132:135], v[84:87]
    v_mfma_f32_16x16x32_bf16 v[84:87], a[184:187], a[136:139], v[84:87]
    v_mfma_f32_16x16x32_bf16 v[84:87], a[188:191], a[140:143], v[84:87]
    s_waitcnt lgkmcnt(5)
    v_mfma_f32_16x16x32_bf16 v[40:43], a[144:147], a[48:51], 0
    s_waitcnt lgkmcnt(4)
    v_mfma_f32_16x16x32_bf16 v[40:43], a[148:151], a[52:55], v[40:43]
    s_waitcnt lgkmcnt(3)
    v_mfma_f32_16x16x32_bf16 v[40:43], a[152:155], a[56:59], v[40:43]
    s_waitcnt lgkmcnt(2)
    v_mfma_f32_16x16x32_bf16 v[40:43], a[156:159], a[60:63], v[40:43]
    s_waitcnt lgkmcnt(1)
    v_mfma_f32_16x16x32_bf16 v[40:43], a[160:163], a[64:67], v[40:43]
    s_waitcnt lgkmcnt(0)
    v_mfma_f32_16x16x32_bf16 v[40:43], a[164:167], a[68:71], v[40:43]
    v_mfma_f32_16x16x32_bf16 v[56:59], a[144:147], a[72:75], 0
    ds_read_b128 a[168:171], v224 offset:18432
    v_mfma_f32_16x16x32_bf16 v[56:59], a[148:151], a[76:79], v[56:59]
    v_mfma_f32_16x16x32_bf16 v[56:59], a[152:155], a[80:83], v[56:59]
    ds_read_b128 a[172:175], v225 offset:18432
    v_mfma_f32_16x16x32_bf16 v[56:59], a[156:159], a[84:87], v[56:59]
    v_mfma_f32_16x16x32_bf16 v[56:59], a[160:163], a[88:91], v[56:59]
    v_mfma_f32_16x16x32_bf16 v[56:59], a[164:167], a[92:95], v[56:59]
    ds_read_b128 a[176:179], v224 offset:18560
    v_mfma_f32_16x16x32_bf16 v[72:75], a[144:147], a[96:99], 0
    v_mfma_f32_16x16x32_bf16 v[72:75], a[148:151], a[100:103], v[72:75]
    ds_read_b128 a[180:183], v225 offset:18560
    v_mfma_f32_16x16x32_bf16 v[72:75], a[152:155], a[104:107], v[72:75]
    v_mfma_f32_16x16x32_bf16 v[72:75], a[156:159], a[108:111], v[72:75]
    v_mfma_f32_16x16x32_bf16 v[72:75], a[160:163], a[112:115], v[72:75]
    ds_read_b128 a[184:187], v224 offset:18688
    v_mfma_f32_16x16x32_bf16 v[72:75], a[164:167], a[116:119], v[72:75]
    v_mfma_f32_16x16x32_bf16 v[88:91], a[144:147], a[120:123], 0
    v_mfma_f32_16x16x32_bf16 v[88:91], a[148:151], a[124:127], v[88:91]
    ds_read_b128 a[188:191], v225 offset:18688
    v_mfma_f32_16x16x32_bf16 v[88:91], a[152:155], a[128:131], v[88:91]
    v_mfma_f32_16x16x32_bf16 v[88:91], a[156:159], a[132:135], v[88:91]
    v_mfma_f32_16x16x32_bf16 v[88:91], a[160:163], a[136:139], v[88:91]
    v_mfma_f32_16x16x32_bf16 v[88:91], a[164:167], a[140:143], v[88:91]
    s_waitcnt lgkmcnt(5)
    v_mfma_f32_16x16x32_bf16 v[44:47], a[168:171], a[48:51], 0
    s_add_u32 s23, s23, 1
    s_cmp_eq_u32 s23, 5
    s_cselect_b32 s26, 4294868992, s39
    s_cselect_b32 s23, 0, s23
    s_waitcnt lgkmcnt(4)
    v_mfma_f32_16x16x32_bf16 v[44:47], a[172:175], a[52:55], v[44:47]
    s_waitcnt lgkmcnt(3)
    v_mfma_f32_16x16x32_bf16 v[44:47], a[176:179], a[56:59], v[44:47]
    s_waitcnt lgkmcnt(2)
    v_mfma_f32_16x16x32_bf16 v[44:47], a[180:183], a[60:63], v[44:47]
    v_add_u32 v224, s26, v224
    s_waitcnt lgkmcnt(1)
    v_mfma_f32_16x16x32_bf16 v[44:47], a[184:187], a[64:67], v[44:47]
    s_waitcnt lgkmcnt(0)
    v_mfma_f32_16x16x32_bf16 v[44:47], a[188:191], a[68:71], v[44:47]
    v_mfma_f32_16x16x32_bf16 v[60:63], a[168:171], a[72:75], 0
    v_add_u32 v225, s26, v225
    v_mfma_f32_16x16x32_bf16 v[60:63], a[172:175], a[76:79], v[60:63]
    v_mfma_f32_16x16x32_bf16 v[60:63], a[176:179], a[80:83], v[60:63]
    v_mfma_f32_16x16x32_bf16 v[60:63], a[180:183], a[84:87], v[60:63]
    v_mfma_f32_16x16x32_bf16 v[60:63], a[184:187], a[88:91], v[60:63]
    v_mfma_f32_16x16x32_bf16 v[60:63], a[188:191], a[92:95], v[60:63]
    s_waitcnt vmcnt(0)
    s_barrier
    s_add_u32 s31, s22, 768
    s_mul_hi_u32 s29, s31, 89478486
    v_mfma_f32_16x16x32_bf16 v[76:79], a[168:171], a[96:99], 0
    s_mul_i32 s30, s29, 48
    s_sub_u32 s30, s31, s30
    s_mul_i32 s29, s29, 1179648
    v_mfma_f32_16x16x32_bf16 v[76:79], a[172:175], a[100:103], v[76:79]
    s_mul_i32 s30, s30, 3072
    s_add_u32 s32, s29, s30
    s_add_u32 s32, s32, s38
    v_mfma_f32_16x16x32_bf16 v[76:79], a[176:179], a[104:107], v[76:79]
    s_add_u32 s36, s34, 0
    s_add_u32 s37, s32, 0
    s_mov_b32 m0, s36
    v_mfma_f32_16x16x32_bf16 v[76:79], a[180:183], a[108:111], v[76:79]
    ds_read_b128 a[144:147], v224 offset:0
    v_mfma_f32_16x16x32_bf16 v[76:79], a[184:187], a[112:115], v[76:79]
    ds_read_b128 a[148:151], v225 offset:0
    ds_read_b128 a[152:155], v224 offset:128
    v_mfma_f32_16x16x32_bf16 v[76:79], a[188:191], a[116:119], v[76:79]
    buffer_load_dwordx4 v227, s[8:11], s37 offen offset:0 nt lds
    v_mfma_f32_16x16x32_bf16 v[92:95], a[168:171], a[120:123], 0
    ds_read_b128 a[156:159], v225 offset:128
    v_mfma_f32_16x16x32_bf16 v[92:95], a[172:175], a[124:127], v[92:95]
    ds_read_b128 a[160:163], v224 offset:256
    ds_read_b128 a[164:167], v225 offset:256
    v_mfma_f32_16x16x32_bf16 v[92:95], a[176:179], a[128:131], v[92:95]
    buffer_load_dwordx4 v228, s[8:11], s37 offen offset:1024 nt lds
    v_mfma_f32_16x16x32_bf16 v[92:95], a[180:183], a[132:135], v[92:95]
    v_mfma_f32_16x16x32_bf16 v[92:95], a[184:187], a[136:139], v[92:95]
    v_cvt_pk_bf16_f32 v96, v0, v1
    v_mfma_f32_16x16x32_bf16 v[92:95], a[188:191], a[140:143], v[92:95]
    v_cvt_pk_bf16_f32 v97, v2, v3
    s_add_u32 s36, s34, 6144
    s_waitcnt lgkmcnt(5)
    v_mfma_f32_16x16x32_bf16 v[0:3], a[144:147], a[0:3], 0
    buffer_load_dwordx4 v229, s[8:11], s37 offen offset:2048 nt lds
    s_waitcnt lgkmcnt(4)
    v_mfma_f32_16x16x32_bf16 v[0:3], a[148:151], a[4:7], v[0:3]
    s_add_u32 s37, s32, 294912
    s_waitcnt lgkmcnt(3)
    v_mfma_f32_16x16x32_bf16 v[0:3], a[152:155], a[8:11], v[0:3]
    s_mov_b32 m0, s36
    v_cvt_pk_bf16_f32 v104, v16, v17
    s_waitcnt lgkmcnt(2)
    v_mfma_f32_16x16x32_bf16 v[0:3], a[156:159], a[12:15], v[0:3]
    buffer_load_dwordx4 v227, s[8:11], s37 offen offset:0 nt lds
    s_waitcnt lgkmcnt(1)
    v_mfma_f32_16x16x32_bf16 v[0:3], a[160:163], a[16:19], v[0:3]
    v_cvt_pk_bf16_f32 v105, v18, v19
    s_waitcnt lgkmcnt(0)
    v_mfma_f32_16x16x32_bf16 v[0:3], a[164:167], a[20:23], v[0:3]
    v_cvt_pk_bf16_f32 v112, v32, v33
    v_mfma_f32_16x16x32_bf16 v[16:19], a[144:147], a[24:27], 0
    v_cvt_pk_bf16_f32 v113, v34, v35
    s_add_u32 s36, s34, 12288
    v_mfma_f32_16x16x32_bf16 v[16:19], a[148:151], a[28:31], v[16:19]
    buffer_load_dwordx4 v228, s[8:11], s37 offen offset:1024 nt lds
    v_mfma_f32_16x16x32_bf16 v[16:19], a[152:155], a[32:35], v[16:19]
    v_cvt_pk_bf16_f32 v120, v48, v49
    v_mfma_f32_16x16x32_bf16 v[16:19], a[156:159], a[36:39], v[16:19]
    v_cvt_pk_bf16_f32 v121, v50, v51
    s_add_u32 s31, s22, 1024
    v_mfma_f32_16x16x32_bf16 v[16:19], a[160:163], a[40:43], v[16:19]
    buffer_load_dwordx4 v229, s[8:11], s37 offen offset:2048 nt lds
    v_mfma_f32_16x16x32_bf16 v[16:19], a[164:167], a[44:47], v[16:19]
    s_add_u32 s37, s32, 589824
    v_mfma_f32_16x16x32_bf16 v[32:35], a[144:147], a[48:51], 0
    s_mov_b32 m0, s36
    v_cvt_pk_bf16_f32 v98, v4, v5
    v_mfma_f32_16x16x32_bf16 v[32:35], a[148:151], a[52:55], v[32:35]
    v_cvt_pk_bf16_f32 v128, v64, v65
    s_add_u32 s36, s34, 18432
    v_mfma_f32_16x16x32_bf16 v[32:35], a[152:155], a[56:59], v[32:35]
    buffer_load_dwordx4 v227, s[8:11], s37 offen offset:0 nt lds
    v_mfma_f32_16x16x32_bf16 v[32:35], a[156:159], a[60:63], v[32:35]
    v_mfma_f32_16x16x32_bf16 v[32:35], a[160:163], a[64:67], v[32:35]
    buffer_load_dwordx4 v228, s[8:11], s37 offen offset:1024 nt lds
    v_mfma_f32_16x16x32_bf16 v[32:35], a[164:167], a[68:71], v[32:35]
    v_cvt_pk_bf16_f32 v129, v66, v67
    v_mfma_f32_16x16x32_bf16 v[48:51], a[144:147], a[72:75], 0
    v_cvt_pk_bf16_f32 v99, v6, v7
    v_mfma_f32_16x16x32_bf16 v[48:51], a[148:151], a[76:79], v[48:51]
    buffer_load_dwordx4 v229, s[8:11], s37 offen offset:2048 nt lds
    v_mfma_f32_16x16x32_bf16 v[48:51], a[152:155], a[80:83], v[48:51]
    s_add_u32 s37, s32, 884736
    s_mov_b32 m0, s36
    v_mfma_f32_16x16x32_bf16 v[48:51], a[156:159], a[84:87], v[48:51]
    v_cvt_pk_bf16_f32 v136, v80, v81
    v_mfma_f32_16x16x32_bf16 v[48:51], a[160:163], a[88:91], v[48:51]
    buffer_load_dwordx4 v227, s[8:11], s37 offen offset:0 nt lds
    v_mfma_f32_16x16x32_bf16 v[48:51], a[164:167], a[92:95], v[48:51]
    v_cvt_pk_bf16_f32 v137, v82, v83
    v_mfma_f32_16x16x32_bf16 v[64:67], a[144:147], a[96:99], 0
    ds_read_b128 a[168:171], v224 offset:6144
    v_mfma_f32_16x16x32_bf16 v[64:67], a[148:151], a[100:103], v[64:67]
    ds_read_b128 a[172:175], v225 offset:6144
    ds_read_b128 a[176:179], v224 offset:6272
    v_mfma_f32_16x16x32_bf16 v[64:67], a[152:155], a[104:107], v[64:67]
    ds_read_b128 a[180:183], v225 offset:6272
    v_mfma_f32_16x16x32_bf16 v[64:67], a[156:159], a[108:111], v[64:67]
    ds_read_b128 a[184:187], v224 offset:6400
    v_mfma_f32_16x16x32_bf16 v[64:67], a[160:163], a[112:115], v[64:67]
    buffer_load_dwordx4 v228, s[8:11], s37 offen offset:1024 nt lds
    v_mfma_f32_16x16x32_bf16 v[64:67], a[164:167], a[116:119], v[64:67]
    ds_read_b128 a[188:191], v225 offset:6400
    v_mfma_f32_16x16x32_bf16 v[80:83], a[144:147], a[120:123], 0
    s_add_u32 s35, s35, 1
    s_add_u32 s34, s34, 24576
    s_cmp_eq_u32 s35, 5
    s_cselect_b32 s35, 0, s35
    s_cselect_b32 s29, 122880, 0
    s_sub_u32 s34, s34, s29
    v_mfma_f32_16x16x32_bf16 v[80:83], a[148:151], a[124:127], v[80:83]
    buffer_load_dwordx4 v229, s[8:11], s37 offen offset:2048 nt lds
    v_mfma_f32_16x16x32_bf16 v[80:83], a[152:155], a[128:131], v[80:83]
    s_mul_hi_u32 s29, s31, 89478486
    s_mul_i32 s30, s29, 48
    v_mfma_f32_16x16x32_bf16 v[80:83], a[156:159], a[132:135], v[80:83]
    s_sub_u32 s30, s31, s30
    s_mul_i32 s29, s29, 1179648
    s_mul_i32 s30, s30, 3072
    s_add_u32 s32, s29, s30
    v_mfma_f32_16x16x32_bf16 v[80:83], a[160:163], a[136:139], v[80:83]
    s_add_u32 s32, s32, s38
    s_add_u32 s36, s34, 0
    s_add_u32 s37, s32, 0
    s_mov_b32 m0, s36
    v_mfma_f32_16x16x32_bf16 v[80:83], a[164:167], a[140:143], v[80:83]
    buffer_load_dwordx4 v227, s[8:11], s37 offen offset:0 nt lds
    s_waitcnt lgkmcnt(5)
    v_mfma_f32_16x16x32_bf16 v[4:7], a[168:171], a[0:3], 0
    s_waitcnt lgkmcnt(4)
    v_mfma_f32_16x16x32_bf16 v[4:7], a[172:175], a[4:7], v[4:7]
    s_waitcnt lgkmcnt(3)
    v_mfma_f32_16x16x32_bf16 v[4:7], a[176:179], a[8:11], v[4:7]
    buffer_load_dwordx4 v228, s[8:11], s37 offen offset:1024 nt lds
    s_waitcnt lgkmcnt(2)
    v_mfma_f32_16x16x32_bf16 v[4:7], a[180:183], a[12:15], v[4:7]
    s_waitcnt lgkmcnt(1)
    v_mfma_f32_16x16x32_bf16 v[4:7], a[184:187], a[16:19], v[4:7]
    v_cvt_pk_bf16_f32 v106, v20, v21
    s_add_u32 s36, s34, 6144
    s_waitcnt lgkmcnt(0)
    v_mfma_f32_16x16x32_bf16 v[4:7], a[188:191], a[20:23], v[4:7]
    v_cvt_pk_bf16_f32 v107, v22, v23
    s_add_u32 s31, s22, 1280
    v_mfma_f32_16x16x32_bf16 v[20:23], a[168:171], a[24:27], 0
    buffer_load_dwordx4 v229, s[8:11], s37 offen offset:2048 nt lds
    v_mfma_f32_16x16x32_bf16 v[20:23], a[172:175], a[28:31], v[20:23]
    s_add_u32 s37, s32, 294912
    v_mfma_f32_16x16x32_bf16 v[20:23], a[176:179], a[32:35], v[20:23]
    s_mov_b32 m0, s36
    v_cvt_pk_bf16_f32 v114, v36, v37
    v_mfma_f32_16x16x32_bf16 v[20:23], a[180:183], a[36:39], v[20:23]
    buffer_load_dwordx4 v227, s[8:11], s37 offen offset:0 nt lds
    v_mfma_f32_16x16x32_bf16 v[20:23], a[184:187], a[40:43], v[20:23]
    v_cvt_pk_bf16_f32 v115, v38, v39
    v_mfma_f32_16x16x32_bf16 v[20:23], a[188:191], a[44:47], v[20:23]
    v_cvt_pk_bf16_f32 v122, v52, v53
    v_mfma_f32_16x16x32_bf16 v[36:39], a[168:171], a[48:51], 0
    v_cvt_pk_bf16_f32 v123, v54, v55
    s_add_u32 s36, s34, 12288
    v_mfma_f32_16x16x32_bf16 v[36:39], a[172:175], a[52:55], v[36:39]
    buffer_load_dwordx4 v228, s[8:11], s37 offen offset:1024 nt lds
    v_mfma_f32_16x16x32_bf16 v[36:39], a[176:179], a[56:59], v[36:39]
    v_cvt_pk_bf16_f32 v130, v68, v69
    v_mfma_f32_16x16x32_bf16 v[36:39], a[180:183], a[60:63], v[36:39]
    v_cvt_pk_bf16_f32 v131, v70, v71
    v_mfma_f32_16x16x32_bf16 v[36:39], a[184:187], a[64:67], v[36:39]
    buffer_load_dwordx4 v229, s[8:11], s37 offen offset:2048 nt lds
    v_mfma_f32_16x16x32_bf16 v[36:39], a[188:191], a[68:71], v[36:39]
    s_add_u32 s37, s32, 589824
    s_mov_b32 m0, s36
    v_mfma_f32_16x16x32_bf16 v[52:55], a[168:171], a[72:75], 0
    v_cvt_pk_bf16_f32 v138, v84, v85
    s_add_u32 s36, s34, 18432
    v_mfma_f32_16x16x32_bf16 v[52:55], a[172:175], a[76:79], v[52:55]
    v_cvt_pk_bf16_f32 v139, v86, v87
    v_mfma_f32_16x16x32_bf16 v[52:55], a[176:179], a[80:83], v[52:55]
    buffer_load_dwordx4 v227, s[8:11], s37 offen offset:0 nt lds
    v_mfma_f32_16x16x32_bf16 v[52:55], a[180:183], a[84:87], v[52:55]
    ds_read_b128 a[144:147], v224 offset:12288
    v_mfma_f32_16x16x32_bf16 v[52:55], a[184:187], a[88:91], v[52:55]
    ds_read_b128 a[148:151], v225 offset:12288
    v_mfma_f32_16x16x32_bf16 v[52:55], a[188:191], a[92:95], v[52:55]
    buffer_load_dwordx4 v228, s[8:11], s37 offen offset:1024 nt lds
    v_mfma_f32_16x16x32_bf16 v[68:71], a[168:171], a[96:99], 0
    ds_read_b128 a[152:155], v224 offset:12416
    v_mfma_f32_16x16x32_bf16 v[68:71], a[172:175], a[100:103], v[68:71]
    ds_read_b128 a[156:159], v225 offset:12416
    v_mfma_f32_16x16x32_bf16 v[68:71], a[176:179], a[104:107], v[68:71]
    buffer_load_dwordx4 v229, s[8:11], s37 offen offset:2048 nt lds
    v_mfma_f32_16x16x32_bf16 v[68:71], a[180:183], a[108:111], v[68:71]
    s_add_u32 s37, s32, 884736
    s_mov_b32 m0, s36
    v_mfma_f32_16x16x32_bf16 v[68:71], a[184:187], a[112:115], v[68:71]
    ds_read_b128 a[160:163], v224 offset:12544
    v_mfma_f32_16x16x32_bf16 v[68:71], a[188:191], a[116:119], v[68:71]
    buffer_load_dwordx4 v227, s[8:11], s37 offen offset:0 nt lds
    v_mfma_f32_16x16x32_bf16 v[84:87], a[168:171], a[120:123], 0
    ds_read_b128 a[164:167], v225 offset:12544
    v_mfma_f32_16x16x32_bf16 v[84:87], a[172:175], a[124:127], v[84:87]
    v_cvt_pk_bf16_f32 v100, v8, v9
    v_mfma_f32_16x16x32_bf16 v[84:87], a[176:179], a[128:131], v[84:87]
    v_cvt_pk_bf16_f32 v101, v10, v11
    v_cvt_pk_bf16_f32 v108, v24, v25
    v_mfma_f32_16x16x32_bf16 v[84:87], a[180:183], a[132:135], v[84:87]
    v_cvt_pk_bf16_f32 v109, v26, v27
    v_mfma_f32_16x16x32_bf16 v[84:87], a[184:187], a[136:139], v[84:87]
    buffer_load_dwordx4 v228, s[8:11], s37 offen offset:1024 nt lds
    v_mfma_f32_16x16x32_bf16 v[84:87], a[188:191], a[140:143], v[84:87]
    v_cvt_pk_bf16_f32 v116, v40, v41
    s_waitcnt lgkmcnt(5)
    v_mfma_f32_16x16x32_bf16 v[8:11], a[144:147], a[0:3], 0
    s_add_u32 s35, s35, 1
    s_add_u32 s34, s34, 24576
    s_cmp_eq_u32 s35, 5
    s_cselect_b32 s35, 0, s35
    s_cselect_b32 s29, 122880, 0
    s_sub_u32 s34, s34, s29
    s_waitcnt lgkmcnt(4)
    v_mfma_f32_16x16x32_bf16 v[8:11], a[148:151], a[4:7], v[8:11]
    buffer_load_dwordx4 v229, s[8:11], s37 offen offset:2048 nt lds
    s_waitcnt lgkmcnt(3)
    v_mfma_f32_16x16x32_bf16 v[8:11], a[152:155], a[8:11], v[8:11]
    s_mul_hi_u32 s29, s31, 89478486
    s_mul_i32 s30, s29, 48
    s_waitcnt lgkmcnt(2)
    v_mfma_f32_16x16x32_bf16 v[8:11], a[156:159], a[12:15], v[8:11]
    s_sub_u32 s30, s31, s30
    s_mul_i32 s29, s29, 1179648
    s_mul_i32 s30, s30, 3072
    s_add_u32 s32, s29, s30
    s_waitcnt lgkmcnt(1)
    v_mfma_f32_16x16x32_bf16 v[8:11], a[160:163], a[16:19], v[8:11]
    s_add_u32 s32, s32, s38
    s_add_u32 s36, s34, 0
    s_add_u32 s37, s32, 0
    s_mov_b32 m0, s36
    s_waitcnt lgkmcnt(0)
    v_mfma_f32_16x16x32_bf16 v[8:11], a[164:167], a[20:23], v[8:11]
    buffer_load_dwordx4 v227, s[8:11], s37 offen offset:0 nt lds
    v_mfma_f32_16x16x32_bf16 v[24:27], a[144:147], a[24:27], 0
    v_mfma_f32_16x16x32_bf16 v[24:27], a[148:151], a[28:31], v[24:27]
    v_mfma_f32_16x16x32_bf16 v[24:27], a[152:155], a[32:35], v[24:27]
    buffer_load_dwordx4 v228, s[8:11], s37 offen offset:1024 nt lds
    v_mfma_f32_16x16x32_bf16 v[24:27], a[156:159], a[36:39], v[24:27]
    v_mfma_f32_16x16x32_bf16 v[24:27], a[160:163], a[40:43], v[24:27]
    v_cvt_pk_bf16_f32 v117, v42, v43
    v_mfma_f32_16x16x32_bf16 v[24:27], a[164:167], a[44:47], v[24:27]
    s_add_u32 s36, s34, 6144
    v_cvt_pk_bf16_f32 v124, v56, v57
    v_mfma_f32_16x16x32_bf16 v[40:43], a[144:147], a[48:51], 0
    buffer_load_dwordx4 v229, s[8:11], s37 offen offset:2048 nt lds
    v_mfma_f32_16x16x32_bf16 v[40:43], a[148:151], a[52:55], v[40:43]
    s_add_u32 s37, s32, 294912
    s_mov_b32 m0, s36
    v_mfma_f32_16x16x32_bf16 v[40:43], a[152:155], a[56:59], v[40:43]
    v_cvt_pk_bf16_f32 v125, v58, v59
    s_add_u32 s36, s34, 12288
    v_mfma_f32_16x16x32_bf16 v[40:43], a[156:159], a[60:63], v[40:43]
    buffer_load_dwordx4 v227, s[8:11], s37 offen offset:0 nt lds
    v_mfma_f32_16x16x32_bf16 v[40:43], a[160:163], a[64:67], v[40:43]
    v_mfma_f32_16x16x32_bf16 v[40:43], a[164:167], a[68:71], v[40:43]
    buffer_load_dwordx4 v228, s[8:11], s37 offen offset:1024 nt lds
    v_mfma_f32_16x16x32_bf16 v[56:59], a[144:147], a[72:75], 0
    v_cvt_pk_bf16_f32 v132, v72, v73
    v_mfma_f32_16x16x32_bf16 v[56:59], a[148:151], a[76:79], v[56:59]
    v_cvt_pk_bf16_f32 v133, v74, v75
    v_mfma_f32_16x16x32_bf16 v[56:59], a[152:155], a[80:83], v[56:59]
    buffer_load_dwordx4 v229, s[8:11], s37 offen offset:2048 nt lds
    v_mfma_f32_16x16x32_bf16 v[56:59], a[156:159], a[84:87], v[56:59]
    v_cvt_pk_bf16_f32 v140, v88, v89
    v_mfma_f32_16x16x32_bf16 v[56:59], a[160:163], a[88:91], v[56:59]
    s_add_u32 s37, s32, 589824
    s_mov_b32 m0, s36
    s_add_u32 s36, s34, 18432
    v_mfma_f32_16x16x32_bf16 v[56:59], a[164:167], a[92:95], v[56:59]
    v_cvt_pk_bf16_f32 v141, v90, v91
    v_mfma_f32_16x16x32_bf16 v[72:75], a[144:147], a[96:99], 0
    buffer_load_dwordx4 v227, s[8:11], s37 offen offset:0 nt lds
    v_mfma_f32_16x16x32_bf16 v[72:75], a[148:151], a[100:103], v[72:75]
    ds_read_b128 a[168:171], v224 offset:18432
    v_mfma_f32_16x16x32_bf16 v[72:75], a[152:155], a[104:107], v[72:75]
    ds_read_b128 a[172:175], v225 offset:18432
    v_mfma_f32_16x16x32_bf16 v[72:75], a[156:159], a[108:111], v[72:75]
    ds_read_b128 a[176:179], v224 offset:18560
    ds_read_b128 a[180:183], v225 offset:18560
    v_mfma_f32_16x16x32_bf16 v[72:75], a[160:163], a[112:115], v[72:75]
    ds_read_b128 a[184:187], v224 offset:18688
    v_mfma_f32_16x16x32_bf16 v[72:75], a[164:167], a[116:119], v[72:75]
    buffer_load_dwordx4 v228, s[8:11], s37 offen offset:1024 nt lds
    v_mfma_f32_16x16x32_bf16 v[88:91], a[144:147], a[120:123], 0
    ds_read_b128 a[188:191], v225 offset:18688
    v_mfma_f32_16x16x32_bf16 v[88:91], a[148:151], a[124:127], v[88:91]
    v_cvt_pk_bf16_f32 v102, v12, v13
    v_mfma_f32_16x16x32_bf16 v[88:91], a[152:155], a[128:131], v[88:91]
    v_cvt_pk_bf16_f32 v103, v14, v15
    v_mfma_f32_16x16x32_bf16 v[88:91], a[156:159], a[132:135], v[88:91]
    buffer_load_dwordx4 v229, s[8:11], s37 offen offset:2048 nt lds
    v_mfma_f32_16x16x32_bf16 v[88:91], a[160:163], a[136:139], v[88:91]
    s_add_u32 s37, s32, 884736
    s_mov_b32 m0, s36
    v_mfma_f32_16x16x32_bf16 v[88:91], a[164:167], a[140:143], v[88:91]
    v_cvt_pk_bf16_f32 v110, v28, v29
    s_waitcnt lgkmcnt(5)
    v_mfma_f32_16x16x32_bf16 v[12:15], a[168:171], a[0:3], 0
    buffer_load_dwordx4 v227, s[8:11], s37 offen offset:0 nt lds
    s_waitcnt lgkmcnt(4)
    v_mfma_f32_16x16x32_bf16 v[12:15], a[172:175], a[4:7], v[12:15]
    v_cvt_pk_bf16_f32 v111, v30, v31
    s_waitcnt lgkmcnt(3)
    v_mfma_f32_16x16x32_bf16 v[12:15], a[176:179], a[8:11], v[12:15]
    v_cvt_pk_bf16_f32 v118, v44, v45
    s_waitcnt lgkmcnt(2)
    v_mfma_f32_16x16x32_bf16 v[12:15], a[180:183], a[12:15], v[12:15]
    buffer_load_dwordx4 v228, s[8:11], s37 offen offset:1024 nt lds
    s_waitcnt lgkmcnt(1)
    v_mfma_f32_16x16x32_bf16 v[12:15], a[184:187], a[16:19], v[12:15]
    v_cvt_pk_bf16_f32 v119, v46, v47
    s_waitcnt lgkmcnt(0)
    v_mfma_f32_16x16x32_bf16 v[12:15], a[188:191], a[20:23], v[12:15]
    v_cvt_pk_bf16_f32 v126, v60, v61
    v_mfma_f32_16x16x32_bf16 v[28:31], a[168:171], a[24:27], 0
    buffer_load_dwordx4 v229, s[8:11], s37 offen offset:2048 nt lds
    v_mfma_f32_16x16x32_bf16 v[28:31], a[172:175], a[28:31], v[28:31]
    v_cvt_pk_bf16_f32 v127, v62, v63
    v_mfma_f32_16x16x32_bf16 v[28:31], a[176:179], a[32:35], v[28:31]
    v_cvt_pk_bf16_f32 v134, v76, v77
    v_mfma_f32_16x16x32_bf16 v[28:31], a[180:183], a[36:39], v[28:31]
    s_add_u32 s23, s23, 1
    s_cmp_eq_u32 s23, 5
    s_cselect_b32 s26, 4294868992, s39
    s_cselect_b32 s23, 0, s23
    v_mfma_f32_16x16x32_bf16 v[28:31], a[184:187], a[40:43], v[28:31]
    v_cvt_pk_bf16_f32 v135, v78, v79
    v_mfma_f32_16x16x32_bf16 v[28:31], a[188:191], a[44:47], v[28:31]
    v_cvt_pk_bf16_f32 v142, v92, v93
    v_mfma_f32_16x16x32_bf16 v[44:47], a[168:171], a[48:51], 0
    v_cvt_pk_bf16_f32 v143, v94, v95
    v_add_u32 v224, s26, v224
    v_mfma_f32_16x16x32_bf16 v[44:47], a[172:175], a[52:55], v[44:47]
    v_add_u32 v225, s26, v225
    v_mfma_f32_16x16x32_bf16 v[44:47], a[176:179], a[56:59], v[44:47]
    v_mfma_f32_16x16x32_bf16 v[44:47], a[180:183], a[60:63], v[44:47]
    s_add_u32 s35, s35, 1
    s_add_u32 s34, s34, 24576
    s_cmp_eq_u32 s35, 5
    s_cselect_b32 s35, 0, s35
    s_cselect_b32 s29, 122880, 0
    s_sub_u32 s34, s34, s29
    v_mfma_f32_16x16x32_bf16 v[44:47], a[184:187], a[64:67], v[44:47]
    v_mfma_f32_16x16x32_bf16 v[44:47], a[188:191], a[68:71], v[44:47]
    v_mfma_f32_16x16x32_bf16 v[60:63], a[168:171], a[72:75], 0
    v_mfma_f32_16x16x32_bf16 v[60:63], a[172:175], a[76:79], v[60:63]
    v_mfma_f32_16x16x32_bf16 v[60:63], a[176:179], a[80:83], v[60:63]
    v_mfma_f32_16x16x32_bf16 v[60:63], a[180:183], a[84:87], v[60:63]
    v_mfma_f32_16x16x32_bf16 v[60:63], a[184:187], a[88:91], v[60:63]
    v_mfma_f32_16x16x32_bf16 v[60:63], a[188:191], a[92:95], v[60:63]
    s_waitcnt vmcnt(24)
    s_barrier
    s_mov_b32 s21, 2
L_o_loop:
    ds_read_b128 a[192:195], v226 offset:0
    v_mfma_f32_16x16x32_bf16 v[76:79], a[168:171], a[96:99], 0
    ds_read_b128 a[196:199], v226 offset:1024
    s_mul_i32 s31, s21, 256
    v_mfma_f32_16x16x32_bf16 v[76:79], a[172:175], a[100:103], v[76:79]
    ds_read_b128 a[200:203], v226 offset:2048
    v_mfma_f32_16x16x32_bf16 v[76:79], a[176:179], a[104:107], v[76:79]
    ds_read_b128 a[204:207], v226 offset:3072
    ds_read_b128 a[208:211], v226 offset:4096
    v_mfma_f32_16x16x32_bf16 v[76:79], a[180:183], a[108:111], v[76:79]
    s_add_u32 s31, s22, s31
    s_add_u32 s31, s31, 1024
    s_mul_hi_u32 s29, s31, 89478486
    v_mfma_f32_16x16x32_bf16 v[76:79], a[184:187], a[112:115], v[76:79]
    s_mul_i32 s30, s29, 48
    s_sub_u32 s30, s31, s30
    s_mul_i32 s29, s29, 1179648
    s_mul_i32 s30, s30, 3072
    v_mfma_f32_16x16x32_bf16 v[76:79], a[188:191], a[116:119], v[76:79]
    s_add_u32 s32, s29, s30
    s_add_u32 s32, s32, s38
    s_cmp_gt_u32 s21, 4
    s_cselect_b32 s32, 1073741824, s32
    v_mfma_f32_16x16x32_bf16 v[92:95], a[168:171], a[120:123], 0
    s_add_u32 s36, s34, 0
    s_add_u32 s37, s32, 0
    s_mov_b32 m0, s36
    v_mfma_f32_16x16x32_bf16 v[92:95], a[172:175], a[124:127], v[92:95]
    buffer_load_dwordx4 v227, s[8:11], s37 offen offset:0 nt lds
    v_mfma_f32_16x16x32_bf16 v[92:95], a[176:179], a[128:131], v[92:95]
    ds_read_b128 a[212:215], v226 offset:5120
    v_mfma_f32_16x16x32_bf16 v[92:95], a[180:183], a[132:135], v[92:95]
    ds_read_b128 a[216:219], v226 offset:6144
    v_mfma_f32_16x16x32_bf16 v[92:95], a[184:187], a[136:139], v[92:95]
    ds_read_b128 a[220:223], v226 offset:7168
    v_mfma_f32_16x16x32_bf16 v[92:95], a[188:191], a[140:143], v[92:95]
    s_waitcnt lgkmcnt(7)
    v_mfma_f32_16x16x32_bf16 v[144:147], v[96:99], a[192:195], 0
    s_waitcnt lgkmcnt(6)
    v_mfma_f32_16x16x32_bf16 v[144:147], v[100:103], a[196:199], v[144:147]
    s_add_u32 s36, s34, 6144
    ds_read_b128 a[144:147], v224 offset:0
    s_waitcnt lgkmcnt(6)
    v_mfma_f32_16x16x32_bf16 v[148:151], v[96:99], a[200:203], 0
    ds_read_b128 a[148:151], v225 offset:0
    s_waitcnt lgkmcnt(6)
    v_mfma_f32_16x16x32_bf16 v[148:151], v[100:103], a[204:207], v[148:151]
    buffer_load_dwordx4 v228, s[8:11], s37 offen offset:1024 nt lds
    s_waitcnt lgkmcnt(5)
    v_mfma_f32_16x16x32_bf16 v[152:155], v[96:99], a[208:211], 0
    s_mul_i32 s51, s21, 256
    s_waitcnt lgkmcnt(4)
    v_mfma_f32_16x16x32_bf16 v[152:155], v[100:103], a[212:215], v[152:155]
    ds_read_b128 a[152:155], v224 offset:128
    s_add_u32 s51, s22, s51
    s_waitcnt lgkmcnt(4)
    v_mfma_f32_16x16x32_bf16 v[156:159], v[96:99], a[216:219], 0
    ds_read_b128 a[156:159], v225 offset:128
    s_waitcnt lgkmcnt(4)
    v_mfma_f32_16x16x32_bf16 v[156:159], v[100:103], a[220:223], v[156:159]
    ds_read_b128 a[160:163], v224 offset:256
    s_sub_u32 s51, s51, 512
    v_mfma_f32_16x16x32_bf16 v[160:163], v[104:107], a[192:195], 0
    ds_read_b128 a[164:167], v225 offset:256
    v_mfma_f32_16x16x32_bf16 v[160:163], v[108:111], a[196:199], v[160:163]
    v_cvt_pk_bf16_f32 v96, v0, v1
    s_mul_hi_u32 s49, s51, 89478486
    v_mfma_f32_16x16x32_bf16 v[164:167], v[104:107], a[200:203], 0
    v_cvt_pk_bf16_f32 v97, v2, v3
    v_mfma_f32_16x16x32_bf16 v[164:167], v[108:111], a[204:207], v[164:167]
    buffer_load_dwordx4 v229, s[8:11], s37 offen offset:2048 nt lds
    v_mfma_f32_16x16x32_bf16 v[168:171], v[104:107], a[208:211], 0
    s_add_u32 s37, s32, 294912
    v_mfma_f32_16x16x32_bf16 v[168:171], v[108:111], a[212:215], v[168:171]
    s_mov_b32 m0, s36
    v_cvt_pk_bf16_f32 v208, v144, v145
    v_mfma_f32_16x16x32_bf16 v[172:175], v[104:107], a[216:219], 0
    v_cvt_pk_bf16_f32 v104, v16, v17
    v_mfma_f32_16x16x32_bf16 v[172:175], v[108:111], a[220:223], v[172:175]
    v_cvt_pk_bf16_f32 v105, v18, v19
    s_add_u32 s36, s34, 12288
    v_mfma_f32_16x16x32_bf16 v[176:179], v[112:115], a[192:195], 0
    v_cvt_pk_bf16_f32 v209, v146, v147
    s_mul_i32 s50, s49, 48
    v_mfma_f32_16x16x32_bf16 v[176:179], v[116:119], a[196:199], v[176:179]
    v_cvt_pk_bf16_f32 v212, v148, v149
    v_mfma_f32_16x16x32_bf16 v[180:183], v[112:115], a[200:203], 0
    v_cvt_pk_bf16_f32 v213, v150, v151
    s_sub_u32 s50, s51, s50
    v_mfma_f32_16x16x32_bf16 v[180:183], v[116:119], a[204:207], v[180:183]
    buffer_load_dwordx4 v227, s[8:11], s37 offen offset:0 nt lds
    v_mfma_f32_16x16x32_bf16 v[184:187], v[112:115], a[208:211], 0
    s_mul_i32 s49, s49, 1179648
    v_mfma_f32_16x16x32_bf16 v[184:187], v[116:119], a[212:215], v[184:187]
    v_cvt_pk_bf16_f32 v216, v152, v153
    v_mfma_f32_16x16x32_bf16 v[188:191], v[112:115], a[216:219], 0
    v_cvt_pk_bf16_f32 v217, v154, v155
    s_mul_i32 s50, s50, 3072
    v_mfma_f32_16x16x32_bf16 v[188:191], v[116:119], a[220:223], v[188:191]
    v_cvt_pk_bf16_f32 v220, v156, v157
    v_mfma_f32_16x16x32_bf16 v[192:195], v[120:123], a[192:195], 0
    v_cvt_pk_bf16_f32 v221, v158, v159
    s_add_u32 s33, s49, s50
    v_mfma_f32_16x16x32_bf16 v[192:195], v[124:127], a[196:199], v[192:195]
    v_cvt_pk_bf16_f32 v210, v160, v161
    v_mfma_f32_16x16x32_bf16 v[196:199], v[120:123], a[200:203], 0
    v_cvt_pk_bf16_f32 v211, v162, v163
    s_add_u32 s48, s33, 0
    v_mfma_f32_16x16x32_bf16 v[196:199], v[124:127], a[204:207], v[196:199]
    buffer_load_dwordx4 v228, s[8:11], s37 offen offset:1024 nt lds
    v_mfma_f32_16x16x32_bf16 v[200:203], v[120:123], a[208:211], 0
    v_mfma_f32_16x16x32_bf16 v[200:203], v[124:127], a[212:215], v[200:203]
    v_cvt_pk_bf16_f32 v214, v164, v165
    v_cvt_pk_bf16_f32 v215, v166, v167
    v_mfma_f32_16x16x32_bf16 v[204:207], v[120:123], a[216:219], 0
    v_cvt_pk_bf16_f32 v218, v168, v169
    v_mfma_f32_16x16x32_bf16 v[204:207], v[124:127], a[220:223], v[204:207]
    v_cvt_pk_bf16_f32 v219, v170, v171
    s_waitcnt lgkmcnt(5)
    v_mfma_f32_16x16x32_bf16 v[0:3], a[144:147], a[0:3], 0
    v_cvt_pk_bf16_f32 v222, v172, v173
    s_waitcnt lgkmcnt(4)
    v_mfma_f32_16x16x32_bf16 v[0:3], a[148:151], a[4:7], v[0:3]
    buffer_load_dwordx4 v229, s[8:11], s37 offen offset:2048 nt lds
    s_waitcnt lgkmcnt(3)
    v_mfma_f32_16x16x32_bf16 v[0:3], a[152:155], a[8:11], v[0:3]
    s_add_u32 s37, s32, 589824
    s_mov_b32 m0, s36
    s_waitcnt lgkmcnt(2)
    v_mfma_f32_16x16x32_bf16 v[0:3], a[156:159], a[12:15], v[0:3]
    v_cvt_pk_bf16_f32 v223, v174, v175
    s_add_u32 s36, s34, 18432
    s_waitcnt lgkmcnt(1)
    v_mfma_f32_16x16x32_bf16 v[0:3], a[160:163], a[16:19], v[0:3]
    v_cvt_pk_bf16_f32 v112, v32, v33
    s_waitcnt lgkmcnt(0)
    v_mfma_f32_16x16x32_bf16 v[0:3], a[164:167], a[20:23], v[0:3]
    v_cvt_pk_bf16_f32 v113, v34, v35
    v_mfma_f32_16x16x32_bf16 v[16:19], a[144:147], a[24:27], 0
    v_cvt_pk_bf16_f32 v120, v48, v49
    v_mfma_f32_16x16x32_bf16 v[16:19], a[148:151], a[28:31], v[16:19]
    v_cvt_pk_bf16_f32 v121, v50, v51
    ds_read_b128 a[168:171], v224 offset:6144
    v_mfma_f32_16x16x32_bf16 v[16:19], a[152:155], a[32:35], v[16:19]
    ds_read_b128 a[172:175], v225 offset:6144
    v_mfma_f32_16x16x32_bf16 v[16:19], a[156:159], a[36:39], v[16:19]
    ds_read_b128 a[176:179], v224 offset:6272
    v_mfma_f32_16x16x32_bf16 v[16:19], a[160:163], a[40:43], v[16:19]
    ds_read_b128 a[180:183], v225 offset:6272
    v_mfma_f32_16x16x32_bf16 v[16:19], a[164:167], a[44:47], v[16:19]
    buffer_load_dwordx4 v227, s[8:11], s37 offen offset:0 nt lds
    v_mfma_f32_16x16x32_bf16 v[144:147], v[128:131], a[192:195], 0
    ds_read_b128 a[184:187], v224 offset:6400
    v_mfma_f32_16x16x32_bf16 v[144:147], v[132:135], a[196:199], v[144:147]
    ds_read_b128 a[188:191], v225 offset:6400
    v_mfma_f32_16x16x32_bf16 v[148:151], v[128:131], a[200:203], 0
    v_cvt_pk_bf16_f32 v98, v4, v5
    v_mfma_f32_16x16x32_bf16 v[148:151], v[132:135], a[204:207], v[148:151]
    v_cvt_pk_bf16_f32 v99, v6, v7
    ds_write_b128 v233, v[208:211] offset:0
    v_mfma_f32_16x16x32_bf16 v[152:155], v[128:131], a[208:211], 0
    v_cvt_pk_bf16_f32 v106, v20, v21
    v_mfma_f32_16x16x32_bf16 v[152:155], v[132:135], a[212:215], v[152:155]
    v_cvt_pk_bf16_f32 v107, v22, v23
    v_mfma_f32_16x16x32_bf16 v[156:159], v[128:131], a[216:219], 0
    v_cvt_pk_bf16_f32 v128, v64, v65
    v_mfma_f32_16x16x32_bf16 v[156:159], v[132:135], a[220:223], v[156:159]
    buffer_load_dwordx4 v228, s[8:11], s37 offen offset:1024 nt lds
    v_mfma_f32_16x16x32_bf16 v[160:163], v[136:139], a[192:195], 0
    v_cvt_pk_bf16_f32 v129, v66, v67
    v_mfma_f32_16x16x32_bf16 v[160:163], v[140:143], a[196:199], v[160:163]
    ds_write_b128 v233, v[212:215] offset:3072
    v_mfma_f32_16x16x32_bf16 v[164:167], v[136:139], a[200:203], 0
    ds_write_b128 v233, v[216:219] offset:6144
    v_mfma_f32_16x16x32_bf16 v[164:167], v[140:143], a[204:207], v[164:167]
    ds_write_b128 v233, v[220:223] offset:9216
    v_cvt_pk_bf16_f32 v208, v176, v177
    v_mfma_f32_16x16x32_bf16 v[168:171], v[136:139], a[208:211], 0
    v_cvt_pk_bf16_f32 v114, v36, v37
    v_mfma_f32_16x16x32_bf16 v[168:171], v[140:143], a[212:215], v[168:171]
    v_cvt_pk_bf16_f32 v209, v178, v179
    v_mfma_f32_16x16x32_bf16 v[172:175], v[136:139], a[216:219], 0
    v_cvt_pk_bf16_f32 v136, v80, v81
    v_mfma_f32_16x16x32_bf16 v[172:175], v[140:143], a[220:223], v[172:175]
    buffer_load_dwordx4 v229, s[8:11], s37 offen offset:2048 nt lds
    v_mfma_f32_16x16x32_bf16 v[32:35], a[144:147], a[48:51], 0
    s_add_u32 s37, s32, 884736
    s_mov_b32 m0, s36
    v_mfma_f32_16x16x32_bf16 v[32:35], a[148:151], a[52:55], v[32:35]
    v_cvt_pk_bf16_f32 v137, v82, v83
    v_mfma_f32_16x16x32_bf16 v[32:35], a[152:155], a[56:59], v[32:35]
    v_cvt_pk_bf16_f32 v115, v38, v39
    v_mfma_f32_16x16x32_bf16 v[32:35], a[156:159], a[60:63], v[32:35]
    v_cvt_pk_bf16_f32 v212, v180, v181
    v_cvt_pk_bf16_f32 v213, v182, v183
    v_mfma_f32_16x16x32_bf16 v[32:35], a[160:163], a[64:67], v[32:35]
    v_cvt_pk_bf16_f32 v216, v184, v185
    v_mfma_f32_16x16x32_bf16 v[32:35], a[164:167], a[68:71], v[32:35]
    v_cvt_pk_bf16_f32 v217, v186, v187
    v_mfma_f32_16x16x32_bf16 v[48:51], a[144:147], a[72:75], 0
    v_cvt_pk_bf16_f32 v220, v188, v189
    v_mfma_f32_16x16x32_bf16 v[48:51], a[148:151], a[76:79], v[48:51]
    buffer_load_dwordx4 v227, s[8:11], s37 offen offset:0 nt lds
    v_mfma_f32_16x16x32_bf16 v[48:51], a[152:155], a[80:83], v[48:51]
    v_cvt_pk_bf16_f32 v210, v192, v193
    v_mfma_f32_16x16x32_bf16 v[48:51], a[156:159], a[84:87], v[48:51]
    v_cvt_pk_bf16_f32 v221, v190, v191
    v_mfma_f32_16x16x32_bf16 v[48:51], a[160:163], a[88:91], v[48:51]
    v_cvt_pk_bf16_f32 v211, v194, v195
    v_mfma_f32_16x16x32_bf16 v[48:51], a[164:167], a[92:95], v[48:51]
    ds_write_b128 v233, v[208:211] offset:64
    v_cvt_pk_bf16_f32 v122, v52, v53
    v_mfma_f32_16x16x32_bf16 v[64:67], a[144:147], a[96:99], 0
    v_cvt_pk_bf16_f32 v123, v54, v55
    v_mfma_f32_16x16x32_bf16 v[64:67], a[148:151], a[100:103], v[64:67]
    v_cvt_pk_bf16_f32 v214, v196, v197
    v_mfma_f32_16x16x32_bf16 v[64:67], a[152:155], a[104:107], v[64:67]
    v_cvt_pk_bf16_f32 v215, v198, v199
    v_mfma_f32_16x16x32_bf16 v[64:67], a[156:159], a[108:111], v[64:67]
    buffer_load_dwordx4 v228, s[8:11], s37 offen offset:1024 nt lds
    v_mfma_f32_16x16x32_bf16 v[64:67], a[160:163], a[112:115], v[64:67]
    ds_write_b128 v233, v[212:215] offset:3136
    v_mfma_f32_16x16x32_bf16 v[64:67], a[164:167], a[116:119], v[64:67]
    v_cvt_pk_bf16_f32 v218, v200, v201
    v_mfma_f32_16x16x32_bf16 v[80:83], a[144:147], a[120:123], 0
    v_cvt_pk_bf16_f32 v219, v202, v203
    v_mfma_f32_16x16x32_bf16 v[80:83], a[148:151], a[124:127], v[80:83]
    ds_write_b128 v233, v[216:219] offset:6208
    v_cvt_pk_bf16_f32 v222, v204, v205
    v_mfma_f32_16x16x32_bf16 v[80:83], a[152:155], a[128:131], v[80:83]
    v_cvt_pk_bf16_f32 v223, v206, v207
    v_mfma_f32_16x16x32_bf16 v[80:83], a[156:159], a[132:135], v[80:83]
    ds_write_b128 v233, v[220:223] offset:9280
    v_mfma_f32_16x16x32_bf16 v[80:83], a[160:163], a[136:139], v[80:83]
    v_cvt_pk_bf16_f32 v208, v144, v145
    v_mfma_f32_16x16x32_bf16 v[80:83], a[164:167], a[140:143], v[80:83]
    buffer_load_dwordx4 v229, s[8:11], s37 offen offset:2048 nt lds
    s_waitcnt lgkmcnt(13)
    v_mfma_f32_16x16x32_bf16 v[4:7], a[168:171], a[0:3], 0
    v_cvt_pk_bf16_f32 v130, v68, v69
    s_waitcnt lgkmcnt(12)
    v_mfma_f32_16x16x32_bf16 v[4:7], a[172:175], a[4:7], v[4:7]
    v_cvt_pk_bf16_f32 v209, v146, v147
    s_waitcnt lgkmcnt(11)
    v_mfma_f32_16x16x32_bf16 v[4:7], a[176:179], a[8:11], v[4:7]
    v_cvt_pk_bf16_f32 v131, v70, v71
    s_waitcnt lgkmcnt(10)
    v_mfma_f32_16x16x32_bf16 v[4:7], a[180:183], a[12:15], v[4:7]
    v_cvt_pk_bf16_f32 v212, v148, v149
    v_cvt_pk_bf16_f32 v213, v150, v151
    s_waitcnt lgkmcnt(9)
    v_mfma_f32_16x16x32_bf16 v[4:7], a[184:187], a[16:19], v[4:7]
    v_cvt_pk_bf16_f32 v216, v152, v153
    s_waitcnt lgkmcnt(8)
    v_mfma_f32_16x16x32_bf16 v[4:7], a[188:191], a[20:23], v[4:7]
    v_cvt_pk_bf16_f32 v217, v154, v155
    v_mfma_f32_16x16x32_bf16 v[20:23], a[168:171], a[24:27], 0
    v_cvt_pk_bf16_f32 v220, v156, v157
    v_mfma_f32_16x16x32_bf16 v[20:23], a[172:175], a[28:31], v[20:23]
    v_cvt_pk_bf16_f32 v210, v160, v161
    v_cvt_pk_bf16_f32 v221, v158, v159
    v_mfma_f32_16x16x32_bf16 v[20:23], a[176:179], a[32:35], v[20:23]
    v_cvt_pk_bf16_f32 v211, v162, v163
    v_mfma_f32_16x16x32_bf16 v[20:23], a[180:183], a[36:39], v[20:23]
    ds_write_b128 v233, v[208:211] offset:128
    v_mfma_f32_16x16x32_bf16 v[20:23], a[184:187], a[40:43], v[20:23]
    v_cvt_pk_bf16_f32 v214, v164, v165
    v_mfma_f32_16x16x32_bf16 v[20:23], a[188:191], a[44:47], v[20:23]
    v_cvt_pk_bf16_f32 v215, v166, v167
    ds_write_b128 v233, v[212:215] offset:3200
    v_mfma_f32_16x16x32_bf16 v[36:39], a[168:171], a[48:51], 0
    v_cvt_pk_bf16_f32 v218, v168, v169
    v_mfma_f32_16x16x32_bf16 v[36:39], a[172:175], a[52:55], v[36:39]
    v_cvt_pk_bf16_f32 v219, v170, v171
    v_mfma_f32_16x16x32_bf16 v[36:39], a[176:179], a[56:59], v[36:39]
    ds_write_b128 v233, v[216:219] offset:6272
    v_mfma_f32_16x16x32_bf16 v[36:39], a[180:183], a[60:63], v[36:39]
    v_cvt_pk_bf16_f32 v222, v172, v173
    v_cvt_pk_bf16_f32 v223, v174, v175
    v_mfma_f32_16x16x32_bf16 v[36:39], a[184:187], a[64:67], v[36:39]
    ds_write_b128 v233, v[220:223] offset:9344
    v_mfma_f32_16x16x32_bf16 v[36:39], a[188:191], a[68:71], v[36:39]
    ds_read_b128 a[224:227], v234 offset:0
    v_mfma_f32_16x16x32_bf16 v[52:55], a[168:171], a[72:75], 0
    ds_read_b128 a[144:147], v224 offset:12288
    v_mfma_f32_16x16x32_bf16 v[52:55], a[172:175], a[76:79], v[52:55]
    v_cvt_pk_bf16_f32 v138, v84, v85
    ds_read_b128 a[148:151], v225 offset:12288
    v_mfma_f32_16x16x32_bf16 v[52:55], a[176:179], a[80:83], v[52:55]
    v_cvt_pk_bf16_f32 v139, v86, v87
    v_mfma_f32_16x16x32_bf16 v[52:55], a[180:183], a[84:87], v[52:55]
    ds_read_b128 a[152:155], v224 offset:12416
    v_mfma_f32_16x16x32_bf16 v[52:55], a[184:187], a[88:91], v[52:55]
    ds_read_b128 a[228:231], v235 offset:0
    v_mfma_f32_16x16x32_bf16 v[52:55], a[188:191], a[92:95], v[52:55]
    ds_read_b128 a[156:159], v225 offset:12416
    ds_read_b128 a[160:163], v224 offset:12544
    v_mfma_f32_16x16x32_bf16 v[68:71], a[168:171], a[96:99], 0
    ds_read_b128 a[164:167], v225 offset:12544
    v_mfma_f32_16x16x32_bf16 v[68:71], a[172:175], a[100:103], v[68:71]
    v_cvt_pk_bf16_f32 v100, v8, v9
    v_mfma_f32_16x16x32_bf16 v[68:71], a[176:179], a[104:107], v[68:71]
    v_cvt_pk_bf16_f32 v101, v10, v11
    v_mfma_f32_16x16x32_bf16 v[68:71], a[180:183], a[108:111], v[68:71]
    ds_read_b128 a[232:235], v236 offset:0
    ds_read_b128 a[236:239], v234 offset:3072
    v_mfma_f32_16x16x32_bf16 v[68:71], a[184:187], a[112:115], v[68:71]
    v_cvt_pk_bf16_f32 v108, v24, v25
    v_mfma_f32_16x16x32_bf16 v[68:71], a[188:191], a[116:119], v[68:71]
    v_cvt_pk_bf16_f32 v109, v26, v27
    v_mfma_f32_16x16x32_bf16 v[84:87], a[168:171], a[120:123], 0
    v_cvt_pk_bf16_f32 v116, v40, v41
    v_mfma_f32_16x16x32_bf16 v[84:87], a[172:175], a[124:127], v[84:87]
    s_waitcnt lgkmcnt(9)
    buffer_store_dwordx4 a[224:227], v230, s[12:15], s48 offen offset:0 sc1
    v_mfma_f32_16x16x32_bf16 v[84:87], a[176:179], a[128:131], v[84:87]
    ds_read_b128 a[240:243], v235 offset:3072
    v_mfma_f32_16x16x32_bf16 v[84:87], a[180:183], a[132:135], v[84:87]
    v_cvt_pk_bf16_f32 v117, v42, v43
    v_mfma_f32_16x16x32_bf16 v[84:87], a[184:187], a[136:139], v[84:87]
    ds_read_b128 a[244:247], v236 offset:3072
    v_mfma_f32_16x16x32_bf16 v[84:87], a[188:191], a[140:143], v[84:87]
    s_waitcnt lgkmcnt(7)
    buffer_store_dwordx4 a[228:231], v231, s[12:15], s48 offen offset:0 sc1
    v_mfma_f32_16x16x32_bf16 v[8:11], a[144:147], a[0:3], 0
    v_cvt_pk_bf16_f32 v124, v56, v57
    v_mfma_f32_16x16x32_bf16 v[8:11], a[148:151], a[4:7], v[8:11]
    v_cvt_pk_bf16_f32 v125, v58, v59
    v_mfma_f32_16x16x32_bf16 v[8:11], a[152:155], a[8:11], v[8:11]
    ds_read_b128 a[248:251], v234 offset:6144
    s_waitcnt lgkmcnt(7)
    v_mfma_f32_16x16x32_bf16 v[8:11], a[156:159], a[12:15], v[8:11]
    s_waitcnt lgkmcnt(4)
    buffer_store_dwordx4 a[232:235], v232, s[12:15], s48 offen offset:0 sc1
    v_mfma_f32_16x16x32_bf16 v[8:11], a[160:163], a[16:19], v[8:11]
    s_add_u32 s48, s33, 294912
    v_mfma_f32_16x16x32_bf16 v[8:11], a[164:167], a[20:23], v[8:11]
    v_cvt_pk_bf16_f32 v132, v72, v73
    v_cvt_pk_bf16_f32 v133, v74, v75
    v_mfma_f32_16x16x32_bf16 v[24:27], a[144:147], a[24:27], 0
    ds_read_b128 a[252:255], v235 offset:6144
    v_mfma_f32_16x16x32_bf16 v[24:27], a[148:151], a[28:31], v[24:27]
    v_cvt_pk_bf16_f32 v140, v88, v89
    v_mfma_f32_16x16x32_bf16 v[24:27], a[152:155], a[32:35], v[24:27]
    ds_read_b128 a[168:171], v224 offset:18432
    v_mfma_f32_16x16x32_bf16 v[24:27], a[156:159], a[36:39], v[24:27]
    s_waitcnt lgkmcnt(5)
    buffer_store_dwordx4 a[236:239], v230, s[12:15], s48 offen offset:0 sc1
    v_mfma_f32_16x16x32_bf16 v[24:27], a[160:163], a[40:43], v[24:27]
    v_cvt_pk_bf16_f32 v141, v90, v91
    v_mfma_f32_16x16x32_bf16 v[24:27], a[164:167], a[44:47], v[24:27]
    ds_read_b128 a[172:175], v225 offset:18432
    v_mfma_f32_16x16x32_bf16 v[40:43], a[144:147], a[48:51], 0
    ds_read_b128 a[224:227], v236 offset:6144
    v_mfma_f32_16x16x32_bf16 v[40:43], a[148:151], a[52:55], v[40:43]
    s_waitcnt lgkmcnt(6)
    buffer_store_dwordx4 a[240:243], v231, s[12:15], s48 offen offset:0 sc1
    v_mfma_f32_16x16x32_bf16 v[40:43], a[152:155], a[56:59], v[40:43]
    ds_read_b128 a[176:179], v224 offset:18560
    v_mfma_f32_16x16x32_bf16 v[40:43], a[156:159], a[60:63], v[40:43]
    ds_read_b128 a[180:183], v225 offset:18560
    v_mfma_f32_16x16x32_bf16 v[40:43], a[160:163], a[64:67], v[40:43]
    ds_read_b128 a[184:187], v224 offset:18688
    v_mfma_f32_16x16x32_bf16 v[40:43], a[164:167], a[68:71], v[40:43]
    ds_read_b128 a[188:191], v225 offset:18688
    ds_read_b128 a[228:231], v234 offset:9216
    v_mfma_f32_16x16x32_bf16 v[56:59], a[144:147], a[72:75], 0
    v_cvt_pk_bf16_f32 v102, v12, v13
    v_mfma_f32_16x16x32_bf16 v[56:59], a[148:151], a[76:79], v[56:59]
    v_cvt_pk_bf16_f32 v103, v14, v15
    v_mfma_f32_16x16x32_bf16 v[56:59], a[152:155], a[80:83], v[56:59]
    v_cvt_pk_bf16_f32 v110, v28, v29
    v_mfma_f32_16x16x32_bf16 v[56:59], a[156:159], a[84:87], v[56:59]
    s_waitcnt lgkmcnt(10)
    buffer_store_dwordx4 a[244:247], v232, s[12:15], s48 offen offset:0 sc1
    v_mfma_f32_16x16x32_bf16 v[56:59], a[160:163], a[88:91], v[56:59]
    s_add_u32 s48, s33, 589824
    v_mfma_f32_16x16x32_bf16 v[56:59], a[164:167], a[92:95], v[56:59]
    s_waitcnt lgkmcnt(9)
    buffer_store_dwordx4 a[248:251], v230, s[12:15], s48 offen offset:0 sc1
    v_mfma_f32_16x16x32_bf16 v[72:75], a[144:147], a[96:99], 0
    ds_read_b128 a[232:235], v235 offset:9216
    v_mfma_f32_16x16x32_bf16 v[72:75], a[148:151], a[100:103], v[72:75]
    v_cvt_pk_bf16_f32 v111, v30, v31
    v_mfma_f32_16x16x32_bf16 v[72:75], a[152:155], a[104:107], v[72:75]
    ds_read_b128 a[236:239], v236 offset:9216
    v_mfma_f32_16x16x32_bf16 v[72:75], a[156:159], a[108:111], v[72:75]
    v_cvt_pk_bf16_f32 v118, v44, v45
    v_cvt_pk_bf16_f32 v119, v46, v47
    v_mfma_f32_16x16x32_bf16 v[72:75], a[160:163], a[112:115], v[72:75]
    v_cvt_pk_bf16_f32 v126, v60, v61
    v_mfma_f32_16x16x32_bf16 v[72:75], a[164:167], a[116:119], v[72:75]
    v_cvt_pk_bf16_f32 v127, v62, v63
    v_mfma_f32_16x16x32_bf16 v[88:91], a[144:147], a[120:123], 0
    v_xor_b32 v226, 0x2000, v226
    v_mfma_f32_16x16x32_bf16 v[88:91], a[148:151], a[124:127], v[88:91]
    s_waitcnt lgkmcnt(10)
    buffer_store_dwordx4 a[252:255], v231, s[12:15], s48 offen offset:0 sc1
    v_mfma_f32_16x16x32_bf16 v[88:91], a[152:155], a[128:131], v[88:91]
    v_cvt_pk_bf16_f32 v134, v76, v77
    v_mfma_f32_16x16x32_bf16 v[88:91], a[156:159], a[132:135], v[88:91]
    v_cvt_pk_bf16_f32 v135, v78, v79
    v_mfma_f32_16x16x32_bf16 v[88:91], a[160:163], a[136:139], v[88:91]
    v_cvt_pk_bf16_f32 v142, v92, v93
    v_mfma_f32_16x16x32_bf16 v[88:91], a[164:167], a[140:143], v[88:91]
    s_waitcnt lgkmcnt(7)
    buffer_store_dwordx4 a[224:227], v232, s[12:15], s48 offen offset:0 sc1
    v_mfma_f32_16x16x32_bf16 v[12:15], a[168:171], a[0:3], 0
    s_add_u32 s48, s33, 884736
    v_mfma_f32_16x16x32_bf16 v[12:15], a[172:175], a[4:7], v[12:15]
    s_add_u32 s23, s23, 1
    s_cmp_eq_u32 s23, 5
    s_cselect_b32 s26, 4294868992, s39
    s_cselect_b32 s23, 0, s23
    s_waitcnt lgkmcnt(6)
    v_mfma_f32_16x16x32_bf16 v[12:15], a[176:179], a[8:11], v[12:15]
    v_cvt_pk_bf16_f32 v143, v94, v95
    s_waitcnt lgkmcnt(5)
    v_mfma_f32_16x16x32_bf16 v[12:15], a[180:183], a[12:15], v[12:15]
    v_add_u32 v224, s26, v224
    s_waitcnt lgkmcnt(4)
    v_mfma_f32_16x16x32_bf16 v[12:15], a[184:187], a[16:19], v[12:15]
    v_add_u32 v225, s26, v225
    s_waitcnt lgkmcnt(3)
    v_mfma_f32_16x16x32_bf16 v[12:15], a[188:191], a[20:23], v[12:15]
    s_waitcnt lgkmcnt(2)
    buffer_store_dwordx4 a[228:231], v230, s[12:15], s48 offen offset:0 sc1
    v_mfma_f32_16x16x32_bf16 v[28:31], a[168:171], a[24:27], 0
    v_mfma_f32_16x16x32_bf16 v[28:31], a[172:175], a[28:31], v[28:31]
    s_waitcnt lgkmcnt(1)
    buffer_store_dwordx4 a[232:235], v231, s[12:15], s48 offen offset:0 sc1
    v_mfma_f32_16x16x32_bf16 v[28:31], a[176:179], a[32:35], v[28:31]
    v_mfma_f32_16x16x32_bf16 v[28:31], a[180:183], a[36:39], v[28:31]
    s_add_u32 s35, s35, 1
    s_add_u32 s34, s34, 24576
    s_cmp_eq_u32 s35, 5
    s_cselect_b32 s35, 0, s35
    s_cselect_b32 s29, 122880, 0
    s_sub_u32 s34, s34, s29
    v_mfma_f32_16x16x32_bf16 v[28:31], a[184:187], a[40:43], v[28:31]
    v_mfma_f32_16x16x32_bf16 v[28:31], a[188:191], a[44:47], v[28:31]
    v_mfma_f32_16x16x32_bf16 v[44:47], a[168:171], a[48:51], 0
    s_waitcnt lgkmcnt(0)
    buffer_store_dwordx4 a[236:239], v232, s[12:15], s48 offen offset:0 sc1
    v_mfma_f32_16x16x32_bf16 v[44:47], a[172:175], a[52:55], v[44:47]
    v_mfma_f32_16x16x32_bf16 v[44:47], a[176:179], a[56:59], v[44:47]
    v_mfma_f32_16x16x32_bf16 v[44:47], a[180:183], a[60:63], v[44:47]
    v_mfma_f32_16x16x32_bf16 v[44:47], a[184:187], a[64:67], v[44:47]
    v_mfma_f32_16x16x32_bf16 v[44:47], a[188:191], a[68:71], v[44:47]
    v_mfma_f32_16x16x32_bf16 v[60:63], a[168:171], a[72:75], 0
    v_mfma_f32_16x16x32_bf16 v[60:63], a[172:175], a[76:79], v[60:63]
    v_mfma_f32_16x16x32_bf16 v[60:63], a[176:179], a[80:83], v[60:63]
    v_mfma_f32_16x16x32_bf16 v[60:63], a[180:183], a[84:87], v[60:63]
    v_mfma_f32_16x16x32_bf16 v[60:63], a[184:187], a[88:91], v[60:63]
    v_mfma_f32_16x16x32_bf16 v[60:63], a[188:191], a[92:95], v[60:63]
    s_waitcnt vmcnt(36)
    s_barrier
    s_add_u32 s21, s21, 1
    s_cmp_lt_u32 s21, 5
    s_cbranch_scc1 L_o_loop
L_o_loop2:
    ds_read_b128 a[192:195], v226 offset:0
    v_mfma_f32_16x16x32_bf16 v[76:79], a[168:171], a[96:99], 0
    ds_read_b128 a[196:199], v226 offset:1024
    v_mfma_f32_16x16x32_bf16 v[76:79], a[172:175], a[100:103], v[76:79]
    ds_read_b128 a[200:203], v226 offset:2048
    v_mfma_f32_16x16x32_bf16 v[76:79], a[176:179], a[104:107], v[76:79]
    ds_read_b128 a[204:207], v226 offset:3072
    v_mfma_f32_16x16x32_bf16 v[76:79], a[180:183], a[108:111], v[76:79]
    ds_read_b128 a[208:211], v226 offset:4096
    v_mfma_f32_16x16x32_bf16 v[76:79], a[184:187], a[112:115], v[76:79]
    ds_read_b128 a[212:215], v226 offset:5120
    v_mfma_f32_16x16x32_bf16 v[76:79], a[188:191], a[116:119], v[76:79]
    ds_read_b128 a[216:219], v226 offset:6144
    v_mfma_f32_16x16x32_bf16 v[92:95], a[168:171], a[120:123], 0
    ds_read_b128 a[220:223], v226 offset:7168
    v_mfma_f32_16x16x32_bf16 v[92:95], a[172:175], a[124:127], v[92:95]
    ds_read_b128 a[144:147], v224 offset:0
    v_mfma_f32_16x16x32_bf16 v[92:95], a[176:179], a[128:131], v[92:95]
    ds_read_b128 a[148:151], v225 offset:0
    v_mfma_f32_16x16x32_bf16 v[92:95], a[180:183], a[132:135], v[92:95]
    ds_read_b128 a[152:155], v224 offset:128
    s_mul_i32 s51, s21, 256
    v_mfma_f32_16x16x32_bf16 v[92:95], a[184:187], a[136:139], v[92:95]
    ds_read_b128 a[156:159], v225 offset:128
    v_mfma_f32_16x16x32_bf16 v[92:95], a[188:191], a[140:143], v[92:95]
    ds_read_b128 a[160:163], v224 offset:256
    s_waitcnt lgkmcnt(12)
    v_mfma_f32_16x16x32_bf16 v[144:147], v[96:99], a[192:195], 0
    ds_read_b128 a[164:167], v225 offset:256
    s_waitcnt lgkmcnt(12)
    v_mfma_f32_16x16x32_bf16 v[144:147], v[100:103], a[196:199], v[144:147]
    ds_read_b128 a[168:171], v224 offset:6144
    s_waitcnt lgkmcnt(12)
    v_mfma_f32_16x16x32_bf16 v[148:151], v[96:99], a[200:203], 0
    ds_read_b128 a[172:175], v225 offset:6144
    s_waitcnt lgkmcnt(12)
    v_mfma_f32_16x16x32_bf16 v[148:151], v[100:103], a[204:207], v[148:151]
    ds_read_b128 a[176:179], v224 offset:6272
    s_waitcnt lgkmcnt(12)
    v_mfma_f32_16x16x32_bf16 v[152:155], v[96:99], a[208:211], 0
    ds_read_b128 a[180:183], v225 offset:6272
    s_waitcnt lgkmcnt(12)
    v_mfma_f32_16x16x32_bf16 v[152:155], v[100:103], a[212:215], v[152:155]
    v_cvt_pk_bf16_f32 v208, v144, v145
    s_waitcnt lgkmcnt(11)
    v_mfma_f32_16x16x32_bf16 v[156:159], v[96:99], a[216:219], 0
    v_cvt_pk_bf16_f32 v96, v0, v1
    s_waitcnt lgkmcnt(10)
    v_mfma_f32_16x16x32_bf16 v[156:159], v[100:103], a[220:223], v[156:159]
    v_cvt_pk_bf16_f32 v97, v2, v3
    s_add_u32 s51, s22, s51
    v_mfma_f32_16x16x32_bf16 v[160:163], v[104:107], a[192:195], 0
    v_cvt_pk_bf16_f32 v209, v146, v147
    v_mfma_f32_16x16x32_bf16 v[160:163], v[108:111], a[196:199], v[160:163]
    v_cvt_pk_bf16_f32 v212, v148, v149
    v_mfma_f32_16x16x32_bf16 v[164:167], v[104:107], a[200:203], 0
    v_cvt_pk_bf16_f32 v213, v150, v151
    v_mfma_f32_16x16x32_bf16 v[164:167], v[108:111], a[204:207], v[164:167]
    v_cvt_pk_bf16_f32 v216, v152, v153
    v_mfma_f32_16x16x32_bf16 v[168:171], v[104:107], a[208:211], 0
    v_cvt_pk_bf16_f32 v217, v154, v155
    v_mfma_f32_16x16x32_bf16 v[168:171], v[108:111], a[212:215], v[168:171]
    v_cvt_pk_bf16_f32 v220, v156, v157
    v_mfma_f32_16x16x32_bf16 v[172:175], v[104:107], a[216:219], 0
    v_cvt_pk_bf16_f32 v104, v16, v17
    v_mfma_f32_16x16x32_bf16 v[172:175], v[108:111], a[220:223], v[172:175]
    v_cvt_pk_bf16_f32 v105, v18, v19
    v_mfma_f32_16x16x32_bf16 v[176:179], v[112:115], a[192:195], 0
    v_cvt_pk_bf16_f32 v221, v158, v159
    v_mfma_f32_16x16x32_bf16 v[176:179], v[116:119], a[196:199], v[176:179]
    v_cvt_pk_bf16_f32 v210, v160, v161
    s_sub_u32 s51, s51, 512
    v_mfma_f32_16x16x32_bf16 v[180:183], v[112:115], a[200:203], 0
    v_cvt_pk_bf16_f32 v211, v162, v163
    v_mfma_f32_16x16x32_bf16 v[180:183], v[116:119], a[204:207], v[180:183]
    v_cvt_pk_bf16_f32 v214, v164, v165
    v_mfma_f32_16x16x32_bf16 v[184:187], v[112:115], a[208:211], 0
    v_cvt_pk_bf16_f32 v215, v166, v167
    v_mfma_f32_16x16x32_bf16 v[184:187], v[116:119], a[212:215], v[184:187]
    v_cvt_pk_bf16_f32 v218, v168, v169
    v_mfma_f32_16x16x32_bf16 v[188:191], v[112:115], a[216:219], 0
    v_cvt_pk_bf16_f32 v219, v170, v171
    v_mfma_f32_16x16x32_bf16 v[188:191], v[116:119], a[220:223], v[188:191]
    v_cvt_pk_bf16_f32 v222, v172, v173
    v_mfma_f32_16x16x32_bf16 v[192:195], v[120:123], a[192:195], 0
    v_cvt_pk_bf16_f32 v223, v174, v175
    v_mfma_f32_16x16x32_bf16 v[192:195], v[124:127], a[196:199], v[192:195]
    v_cvt_pk_bf16_f32 v112, v32, v33
    v_mfma_f32_16x16x32_bf16 v[196:199], v[120:123], a[200:203], 0
    v_cvt_pk_bf16_f32 v113, v34, v35
    v_mfma_f32_16x16x32_bf16 v[196:199], v[124:127], a[204:207], v[196:199]
    ds_read_b128 a[184:187], v224 offset:6400
    s_mul_hi_u32 s49, s51, 89478486
    v_mfma_f32_16x16x32_bf16 v[200:203], v[120:123], a[208:211], 0
    ds_read_b128 a[188:191], v225 offset:6400
    v_mfma_f32_16x16x32_bf16 v[200:203], v[124:127], a[212:215], v[200:203]
    v_cvt_pk_bf16_f32 v98, v4, v5
    v_mfma_f32_16x16x32_bf16 v[204:207], v[120:123], a[216:219], 0
    v_cvt_pk_bf16_f32 v120, v48, v49
    v_mfma_f32_16x16x32_bf16 v[204:207], v[124:127], a[220:223], v[204:207]
    v_cvt_pk_bf16_f32 v121, v50, v51
    s_waitcnt lgkmcnt(11)
    v_mfma_f32_16x16x32_bf16 v[0:3], a[144:147], a[0:3], 0
    v_cvt_pk_bf16_f32 v99, v6, v7
    s_waitcnt lgkmcnt(10)
    v_mfma_f32_16x16x32_bf16 v[0:3], a[148:151], a[4:7], v[0:3]
    ds_write_b128 v233, v[208:211] offset:0
    s_waitcnt lgkmcnt(10)
    v_mfma_f32_16x16x32_bf16 v[0:3], a[152:155], a[8:11], v[0:3]
    v_cvt_pk_bf16_f32 v106, v20, v21
    s_waitcnt lgkmcnt(9)
    v_mfma_f32_16x16x32_bf16 v[0:3], a[156:159], a[12:15], v[0:3]
    v_cvt_pk_bf16_f32 v107, v22, v23
    s_waitcnt lgkmcnt(8)
    v_mfma_f32_16x16x32_bf16 v[0:3], a[160:163], a[16:19], v[0:3]
    ds_write_b128 v233, v[212:215] offset:3072
    s_waitcnt lgkmcnt(8)
    v_mfma_f32_16x16x32_bf16 v[0:3], a[164:167], a[20:23], v[0:3]
    ds_write_b128 v233, v[216:219] offset:6144
    s_mul_i32 s50, s49, 48
    v_mfma_f32_16x16x32_bf16 v[16:19], a[144:147], a[24:27], 0
    ds_write_b128 v233, v[220:223] offset:9216
    v_mfma_f32_16x16x32_bf16 v[16:19], a[148:151], a[28:31], v[16:19]
    v_cvt_pk_bf16_f32 v208, v176, v177
    v_mfma_f32_16x16x32_bf16 v[16:19], a[152:155], a[32:35], v[16:19]
    v_cvt_pk_bf16_f32 v114, v36, v37
    v_mfma_f32_16x16x32_bf16 v[16:19], a[156:159], a[36:39], v[16:19]
    v_cvt_pk_bf16_f32 v209, v178, v179
    v_mfma_f32_16x16x32_bf16 v[16:19], a[160:163], a[40:43], v[16:19]
    v_cvt_pk_bf16_f32 v115, v38, v39
    v_mfma_f32_16x16x32_bf16 v[16:19], a[164:167], a[44:47], v[16:19]
    v_cvt_pk_bf16_f32 v212, v180, v181
    v_mfma_f32_16x16x32_bf16 v[144:147], v[128:131], a[192:195], 0
    v_cvt_pk_bf16_f32 v213, v182, v183
    v_mfma_f32_16x16x32_bf16 v[144:147], v[132:135], a[196:199], v[144:147]
    v_cvt_pk_bf16_f32 v216, v184, v185
    v_mfma_f32_16x16x32_bf16 v[148:151], v[128:131], a[200:203], 0
    v_cvt_pk_bf16_f32 v217, v186, v187
    v_mfma_f32_16x16x32_bf16 v[148:151], v[132:135], a[204:207], v[148:151]
    v_cvt_pk_bf16_f32 v220, v188, v189
    s_sub_u32 s50, s51, s50
    v_mfma_f32_16x16x32_bf16 v[152:155], v[128:131], a[208:211], 0
    v_cvt_pk_bf16_f32 v210, v192, v193
    v_mfma_f32_16x16x32_bf16 v[152:155], v[132:135], a[212:215], v[152:155]
    v_cvt_pk_bf16_f32 v221, v190, v191
    v_mfma_f32_16x16x32_bf16 v[156:159], v[128:131], a[216:219], 0
    v_cvt_pk_bf16_f32 v128, v64, v65
    v_mfma_f32_16x16x32_bf16 v[156:159], v[132:135], a[220:223], v[156:159]
    v_cvt_pk_bf16_f32 v129, v66, v67
    v_mfma_f32_16x16x32_bf16 v[160:163], v[136:139], a[192:195], 0
    v_cvt_pk_bf16_f32 v211, v194, v195
    v_mfma_f32_16x16x32_bf16 v[160:163], v[140:143], a[196:199], v[160:163]
    ds_write_b128 v233, v[208:211] offset:64
    v_mfma_f32_16x16x32_bf16 v[164:167], v[136:139], a[200:203], 0
    v_cvt_pk_bf16_f32 v122, v52, v53
    v_mfma_f32_16x16x32_bf16 v[164:167], v[140:143], a[204:207], v[164:167]
    v_cvt_pk_bf16_f32 v123, v54, v55
    v_mfma_f32_16x16x32_bf16 v[168:171], v[136:139], a[208:211], 0
    v_cvt_pk_bf16_f32 v214, v196, v197
    v_mfma_f32_16x16x32_bf16 v[168:171], v[140:143], a[212:215], v[168:171]
    v_cvt_pk_bf16_f32 v215, v198, v199
    v_mfma_f32_16x16x32_bf16 v[172:175], v[136:139], a[216:219], 0
    v_cvt_pk_bf16_f32 v136, v80, v81
    s_mul_i32 s49, s49, 1179648
    v_mfma_f32_16x16x32_bf16 v[172:175], v[140:143], a[220:223], v[172:175]
    v_cvt_pk_bf16_f32 v137, v82, v83
    v_mfma_f32_16x16x32_bf16 v[32:35], a[144:147], a[48:51], 0
    ds_write_b128 v233, v[212:215] offset:3136
    v_mfma_f32_16x16x32_bf16 v[32:35], a[148:151], a[52:55], v[32:35]
    v_cvt_pk_bf16_f32 v218, v200, v201
    v_mfma_f32_16x16x32_bf16 v[32:35], a[152:155], a[56:59], v[32:35]
    v_cvt_pk_bf16_f32 v219, v202, v203
    v_mfma_f32_16x16x32_bf16 v[32:35], a[156:159], a[60:63], v[32:35]
    ds_write_b128 v233, v[216:219] offset:6208
    v_mfma_f32_16x16x32_bf16 v[32:35], a[160:163], a[64:67], v[32:35]
    v_cvt_pk_bf16_f32 v222, v204, v205
    v_mfma_f32_16x16x32_bf16 v[32:35], a[164:167], a[68:71], v[32:35]
    v_cvt_pk_bf16_f32 v223, v206, v207
    v_mfma_f32_16x16x32_bf16 v[48:51], a[144:147], a[72:75], 0
    ds_write_b128 v233, v[220:223] offset:9280
    v_mfma_f32_16x16x32_bf16 v[48:51], a[148:151], a[76:79], v[48:51]
    v_cvt_pk_bf16_f32 v208, v144, v145
    v_mfma_f32_16x16x32_bf16 v[48:51], a[152:155], a[80:83], v[48:51]
    v_cvt_pk_bf16_f32 v130, v68, v69
    s_mul_i32 s50, s50, 3072
    v_mfma_f32_16x16x32_bf16 v[48:51], a[156:159], a[84:87], v[48:51]
    v_cvt_pk_bf16_f32 v209, v146, v147
    v_mfma_f32_16x16x32_bf16 v[48:51], a[160:163], a[88:91], v[48:51]
    v_cvt_pk_bf16_f32 v131, v70, v71
    v_mfma_f32_16x16x32_bf16 v[48:51], a[164:167], a[92:95], v[48:51]
    v_cvt_pk_bf16_f32 v212, v148, v149
    v_mfma_f32_16x16x32_bf16 v[64:67], a[144:147], a[96:99], 0
    v_cvt_pk_bf16_f32 v213, v150, v151
    v_mfma_f32_16x16x32_bf16 v[64:67], a[148:151], a[100:103], v[64:67]
    v_cvt_pk_bf16_f32 v216, v152, v153
    v_mfma_f32_16x16x32_bf16 v[64:67], a[152:155], a[104:107], v[64:67]
    v_cvt_pk_bf16_f32 v217, v154, v155
    v_mfma_f32_16x16x32_bf16 v[64:67], a[156:159], a[108:111], v[64:67]
    v_cvt_pk_bf16_f32 v220, v156, v157
    v_mfma_f32_16x16x32_bf16 v[64:67], a[160:163], a[112:115], v[64:67]
    v_cvt_pk_bf16_f32 v210, v160, v161
    v_mfma_f32_16x16x32_bf16 v[64:67], a[164:167], a[116:119], v[64:67]
    v_cvt_pk_bf16_f32 v221, v158, v159
    v_mfma_f32_16x16x32_bf16 v[80:83], a[144:147], a[120:123], 0
    v_cvt_pk_bf16_f32 v211, v162, v163
    s_add_u32 s33, s49, s50
    v_mfma_f32_16x16x32_bf16 v[80:83], a[148:151], a[124:127], v[80:83]
    ds_write_b128 v233, v[208:211] offset:128
    v_mfma_f32_16x16x32_bf16 v[80:83], a[152:155], a[128:131], v[80:83]
    v_cvt_pk_bf16_f32 v214, v164, v165
    v_mfma_f32_16x16x32_bf16 v[80:83], a[156:159], a[132:135], v[80:83]
    v_cvt_pk_bf16_f32 v215, v166, v167
    v_mfma_f32_16x16x32_bf16 v[80:83], a[160:163], a[136:139], v[80:83]
    ds_write_b128 v233, v[212:215] offset:3200
    v_mfma_f32_16x16x32_bf16 v[80:83], a[164:167], a[140:143], v[80:83]
    v_cvt_pk_bf16_f32 v218, v168, v169
    s_waitcnt lgkmcnt(15)
    v_mfma_f32_16x16x32_bf16 v[4:7], a[168:171], a[0:3], 0
    v_cvt_pk_bf16_f32 v219, v170, v171
    s_waitcnt lgkmcnt(14)
    v_mfma_f32_16x16x32_bf16 v[4:7], a[172:175], a[4:7], v[4:7]
    ds_write_b128 v233, v[216:219] offset:6272
    s_waitcnt lgkmcnt(14)
    v_mfma_f32_16x16x32_bf16 v[4:7], a[176:179], a[8:11], v[4:7]
    v_cvt_pk_bf16_f32 v222, v172, v173
    s_waitcnt lgkmcnt(13)
    v_mfma_f32_16x16x32_bf16 v[4:7], a[180:183], a[12:15], v[4:7]
    v_cvt_pk_bf16_f32 v223, v174, v175
    s_waitcnt lgkmcnt(12)
    v_mfma_f32_16x16x32_bf16 v[4:7], a[184:187], a[16:19], v[4:7]
    ds_write_b128 v233, v[220:223] offset:9344
    s_add_u32 s48, s33, 0
    s_waitcnt lgkmcnt(12)
    v_mfma_f32_16x16x32_bf16 v[4:7], a[188:191], a[20:23], v[4:7]
    ds_read_b128 a[224:227], v234 offset:0
    v_mfma_f32_16x16x32_bf16 v[20:23], a[168:171], a[24:27], 0
    ds_read_b128 a[144:147], v224 offset:12288
    v_mfma_f32_16x16x32_bf16 v[20:23], a[172:175], a[28:31], v[20:23]
    v_cvt_pk_bf16_f32 v138, v84, v85
    v_mfma_f32_16x16x32_bf16 v[20:23], a[176:179], a[32:35], v[20:23]
    ds_read_b128 a[148:151], v225 offset:12288
    v_mfma_f32_16x16x32_bf16 v[20:23], a[180:183], a[36:39], v[20:23]
    v_cvt_pk_bf16_f32 v139, v86, v87
    v_mfma_f32_16x16x32_bf16 v[20:23], a[184:187], a[40:43], v[20:23]
    ds_read_b128 a[152:155], v224 offset:12416
    v_mfma_f32_16x16x32_bf16 v[20:23], a[188:191], a[44:47], v[20:23]
    ds_read_b128 a[228:231], v235 offset:0
    v_mfma_f32_16x16x32_bf16 v[36:39], a[168:171], a[48:51], 0
    ds_read_b128 a[156:159], v225 offset:12416
    v_mfma_f32_16x16x32_bf16 v[36:39], a[172:175], a[52:55], v[36:39]
    ds_read_b128 a[160:163], v224 offset:12544
    v_mfma_f32_16x16x32_bf16 v[36:39], a[176:179], a[56:59], v[36:39]
    ds_read_b128 a[164:167], v225 offset:12544
    v_mfma_f32_16x16x32_bf16 v[36:39], a[180:183], a[60:63], v[36:39]
    v_cvt_pk_bf16_f32 v100, v8, v9
    v_mfma_f32_16x16x32_bf16 v[36:39], a[184:187], a[64:67], v[36:39]
    v_cvt_pk_bf16_f32 v101, v10, v11
    v_mfma_f32_16x16x32_bf16 v[36:39], a[188:191], a[68:71], v[36:39]
    ds_read_b128 a[232:235], v236 offset:0
    v_mfma_f32_16x16x32_bf16 v[52:55], a[168:171], a[72:75], 0
    ds_read_b128 a[236:239], v234 offset:3072
    v_mfma_f32_16x16x32_bf16 v[52:55], a[172:175], a[76:79], v[52:55]
    v_cvt_pk_bf16_f32 v108, v24, v25
    v_mfma_f32_16x16x32_bf16 v[52:55], a[176:179], a[80:83], v[52:55]
    v_cvt_pk_bf16_f32 v109, v26, v27
    v_mfma_f32_16x16x32_bf16 v[52:55], a[180:183], a[84:87], v[52:55]
    v_cvt_pk_bf16_f32 v116, v40, v41
    v_mfma_f32_16x16x32_bf16 v[52:55], a[184:187], a[88:91], v[52:55]
    ds_read_b128 a[240:243], v235 offset:3072
    v_mfma_f32_16x16x32_bf16 v[52:55], a[188:191], a[92:95], v[52:55]
    v_cvt_pk_bf16_f32 v117, v42, v43
    v_mfma_f32_16x16x32_bf16 v[68:71], a[168:171], a[96:99], 0
    ds_read_b128 a[244:247], v236 offset:3072
    v_cvt_pk_bf16_f32 v124, v56, v57
    v_mfma_f32_16x16x32_bf16 v[68:71], a[172:175], a[100:103], v[68:71]
    v_cvt_pk_bf16_f32 v125, v58, v59
    v_mfma_f32_16x16x32_bf16 v[68:71], a[176:179], a[104:107], v[68:71]
    ds_read_b128 a[248:251], v234 offset:6144
    v_mfma_f32_16x16x32_bf16 v[68:71], a[180:183], a[108:111], v[68:71]
    v_cvt_pk_bf16_f32 v132, v72, v73
    v_mfma_f32_16x16x32_bf16 v[68:71], a[184:187], a[112:115], v[68:71]
    v_cvt_pk_bf16_f32 v133, v74, v75
    v_mfma_f32_16x16x32_bf16 v[68:71], a[188:191], a[116:119], v[68:71]
    ds_read_b128 a[252:255], v235 offset:6144
    v_mfma_f32_16x16x32_bf16 v[84:87], a[168:171], a[120:123], 0
    v_cvt_pk_bf16_f32 v140, v88, v89
    v_mfma_f32_16x16x32_bf16 v[84:87], a[172:175], a[124:127], v[84:87]
    ds_read_b128 a[168:171], v224 offset:18432
    v_mfma_f32_16x16x32_bf16 v[84:87], a[176:179], a[128:131], v[84:87]
    s_waitcnt lgkmcnt(14)
    buffer_store_dwordx4 a[224:227], v230, s[12:15], s48 offen offset:0 sc1
    v_mfma_f32_16x16x32_bf16 v[84:87], a[180:183], a[132:135], v[84:87]
    v_mfma_f32_16x16x32_bf16 v[84:87], a[184:187], a[136:139], v[84:87]
    v_cvt_pk_bf16_f32 v141, v90, v91
    v_mfma_f32_16x16x32_bf16 v[84:87], a[188:191], a[140:143], v[84:87]
    ds_read_b128 a[172:175], v225 offset:18432
    s_waitcnt lgkmcnt(14)
    v_mfma_f32_16x16x32_bf16 v[8:11], a[144:147], a[0:3], 0
    ds_read_b128 a[224:227], v236 offset:6144
    s_waitcnt lgkmcnt(14)
    v_mfma_f32_16x16x32_bf16 v[8:11], a[148:151], a[4:7], v[8:11]
    s_waitcnt lgkmcnt(12)
    buffer_store_dwordx4 a[228:231], v231, s[12:15], s48 offen offset:0 sc1
    v_mfma_f32_16x16x32_bf16 v[8:11], a[152:155], a[8:11], v[8:11]
    s_waitcnt lgkmcnt(11)
    v_mfma_f32_16x16x32_bf16 v[8:11], a[156:159], a[12:15], v[8:11]
    ds_read_b128 a[176:179], v224 offset:18560
    s_waitcnt lgkmcnt(11)
    v_mfma_f32_16x16x32_bf16 v[8:11], a[160:163], a[16:19], v[8:11]
    ds_read_b128 a[180:183], v225 offset:18560
    s_waitcnt lgkmcnt(11)
    v_mfma_f32_16x16x32_bf16 v[8:11], a[164:167], a[20:23], v[8:11]
    ds_read_b128 a[184:187], v224 offset:18688
    v_mfma_f32_16x16x32_bf16 v[24:27], a[144:147], a[24:27], 0
    s_waitcnt lgkmcnt(11)
    buffer_store_dwordx4 a[232:235], v232, s[12:15], s48 offen offset:0 sc1
    v_mfma_f32_16x16x32_bf16 v[24:27], a[148:151], a[28:31], v[24:27]
    s_add_u32 s48, s33, 294912
    v_mfma_f32_16x16x32_bf16 v[24:27], a[152:155], a[32:35], v[24:27]
    ds_read_b128 a[188:191], v225 offset:18688
    v_mfma_f32_16x16x32_bf16 v[24:27], a[156:159], a[36:39], v[24:27]
    ds_read_b128 a[228:231], v234 offset:9216
    v_mfma_f32_16x16x32_bf16 v[24:27], a[160:163], a[40:43], v[24:27]
    v_cvt_pk_bf16_f32 v102, v12, v13
    v_mfma_f32_16x16x32_bf16 v[24:27], a[164:167], a[44:47], v[24:27]
    s_waitcnt lgkmcnt(12)
    buffer_store_dwordx4 a[236:239], v230, s[12:15], s48 offen offset:0 sc1
    v_mfma_f32_16x16x32_bf16 v[40:43], a[144:147], a[48:51], 0
    v_mfma_f32_16x16x32_bf16 v[40:43], a[148:151], a[52:55], v[40:43]
    v_cvt_pk_bf16_f32 v103, v14, v15
    v_mfma_f32_16x16x32_bf16 v[40:43], a[152:155], a[56:59], v[40:43]
    v_cvt_pk_bf16_f32 v110, v28, v29
    v_mfma_f32_16x16x32_bf16 v[40:43], a[156:159], a[60:63], v[40:43]
    ds_read_b128 a[232:235], v235 offset:9216
    v_mfma_f32_16x16x32_bf16 v[40:43], a[160:163], a[64:67], v[40:43]
    s_waitcnt lgkmcnt(12)
    buffer_store_dwordx4 a[240:243], v231, s[12:15], s48 offen offset:0 sc1
    v_mfma_f32_16x16x32_bf16 v[40:43], a[164:167], a[68:71], v[40:43]
    v_mfma_f32_16x16x32_bf16 v[56:59], a[144:147], a[72:75], 0
    v_cvt_pk_bf16_f32 v111, v30, v31
    v_mfma_f32_16x16x32_bf16 v[56:59], a[148:151], a[76:79], v[56:59]
    s_waitcnt lgkmcnt(11)
    buffer_store_dwordx4 a[244:247], v232, s[12:15], s48 offen offset:0 sc1
    v_mfma_f32_16x16x32_bf16 v[56:59], a[152:155], a[80:83], v[56:59]
    s_add_u32 s48, s33, 589824
    v_mfma_f32_16x16x32_bf16 v[56:59], a[156:159], a[84:87], v[56:59]
    ds_read_b128 a[236:239], v236 offset:9216
    v_mfma_f32_16x16x32_bf16 v[56:59], a[160:163], a[88:91], v[56:59]
    v_cvt_pk_bf16_f32 v118, v44, v45
    v_mfma_f32_16x16x32_bf16 v[56:59], a[164:167], a[92:95], v[56:59]
    v_cvt_pk_bf16_f32 v119, v46, v47
    v_mfma_f32_16x16x32_bf16 v[72:75], a[144:147], a[96:99], 0
    v_cvt_pk_bf16_f32 v126, v60, v61
    v_mfma_f32_16x16x32_bf16 v[72:75], a[148:151], a[100:103], v[72:75]
    v_cvt_pk_bf16_f32 v127, v62, v63
    v_mfma_f32_16x16x32_bf16 v[72:75], a[152:155], a[104:107], v[72:75]
    s_waitcnt lgkmcnt(11)
    buffer_store_dwordx4 a[248:251], v230, s[12:15], s48 offen offset:0 sc1
    v_mfma_f32_16x16x32_bf16 v[72:75], a[156:159], a[108:111], v[72:75]
    v_mfma_f32_16x16x32_bf16 v[72:75], a[160:163], a[112:115], v[72:75]
    v_xor_b32 v226, 0x2000, v226
    v_mfma_f32_16x16x32_bf16 v[72:75], a[164:167], a[116:119], v[72:75]
    v_cvt_pk_bf16_f32 v134, v76, v77
    v_mfma_f32_16x16x32_bf16 v[88:91], a[144:147], a[120:123], 0
    s_waitcnt lgkmcnt(10)
    buffer_store_dwordx4 a[252:255], v231, s[12:15], s48 offen offset:0 sc1
    v_mfma_f32_16x16x32_bf16 v[88:91], a[148:151], a[124:127], v[88:91]
    v_cvt_pk_bf16_f32 v135, v78, v79
    v_mfma_f32_16x16x32_bf16 v[88:91], a[152:155], a[128:131], v[88:91]
    v_cvt_pk_bf16_f32 v142, v92, v93
    v_mfma_f32_16x16x32_bf16 v[88:91], a[156:159], a[132:135], v[88:91]
    v_cvt_pk_bf16_f32 v143, v94, v95
    v_mfma_f32_16x16x32_bf16 v[88:91], a[160:163], a[136:139], v[88:91]
    v_mfma_f32_16x16x32_bf16 v[88:91], a[164:167], a[140:143], v[88:91]
    s_waitcnt lgkmcnt(7)
    buffer_store_dwordx4 a[224:227], v232, s[12:15], s48 offen offset:0 sc1
    v_mfma_f32_16x16x32_bf16 v[12:15], a[168:171], a[0:3], 0
    s_add_u32 s48, s33, 884736
    v_mfma_f32_16x16x32_bf16 v[12:15], a[172:175], a[4:7], v[12:15]
    s_waitcnt lgkmcnt(6)
    v_mfma_f32_16x16x32_bf16 v[12:15], a[176:179], a[8:11], v[12:15]
    s_waitcnt lgkmcnt(2)
    buffer_store_dwordx4 a[228:231], v230, s[12:15], s48 offen offset:0 sc1
    v_mfma_f32_16x16x32_bf16 v[12:15], a[180:183], a[12:15], v[12:15]
    v_mfma_f32_16x16x32_bf16 v[12:15], a[184:187], a[16:19], v[12:15]
    s_add_u32 s23, s23, 1
    s_cmp_eq_u32 s23, 5
    s_cselect_b32 s26, 4294868992, s39
    s_cselect_b32 s23, 0, s23
    v_mfma_f32_16x16x32_bf16 v[12:15], a[188:191], a[20:23], v[12:15]
    v_add_u32 v224, s26, v224
    v_mfma_f32_16x16x32_bf16 v[28:31], a[168:171], a[24:27], 0
    v_add_u32 v225, s26, v225
    v_mfma_f32_16x16x32_bf16 v[28:31], a[172:175], a[28:31], v[28:31]
    v_mfma_f32_16x16x32_bf16 v[28:31], a[176:179], a[32:35], v[28:31]
    s_waitcnt lgkmcnt(1)
    buffer_store_dwordx4 a[232:235], v231, s[12:15], s48 offen offset:0 sc1
    v_mfma_f32_16x16x32_bf16 v[28:31], a[180:183], a[36:39], v[28:31]
    v_mfma_f32_16x16x32_bf16 v[28:31], a[184:187], a[40:43], v[28:31]
    v_mfma_f32_16x16x32_bf16 v[28:31], a[188:191], a[44:47], v[28:31]
    v_mfma_f32_16x16x32_bf16 v[44:47], a[168:171], a[48:51], 0
    s_waitcnt lgkmcnt(0)
    buffer_store_dwordx4 a[236:239], v232, s[12:15], s48 offen offset:0 sc1
    v_mfma_f32_16x16x32_bf16 v[44:47], a[172:175], a[52:55], v[44:47]
    v_mfma_f32_16x16x32_bf16 v[44:47], a[176:179], a[56:59], v[44:47]
    v_mfma_f32_16x16x32_bf16 v[44:47], a[180:183], a[60:63], v[44:47]
    v_mfma_f32_16x16x32_bf16 v[44:47], a[184:187], a[64:67], v[44:47]
    v_mfma_f32_16x16x32_bf16 v[44:47], a[188:191], a[68:71], v[44:47]
    v_mfma_f32_16x16x32_bf16 v[60:63], a[168:171], a[72:75], 0
    v_mfma_f32_16x16x32_bf16 v[60:63], a[172:175], a[76:79], v[60:63]
    v_mfma_f32_16x16x32_bf16 v[60:63], a[176:179], a[80:83], v[60:63]
    v_mfma_f32_16x16x32_bf16 v[60:63], a[180:183], a[84:87], v[60:63]
    v_mfma_f32_16x16x32_bf16 v[60:63], a[184:187], a[88:91], v[60:63]
    v_mfma_f32_16x16x32_bf16 v[60:63], a[188:191], a[92:95], v[60:63]
    s_waitcnt vmcnt(36)
    s_barrier
    s_add_u32 s21, s21, 1
    s_cmp_lt_u32 s21, 9
    s_cbranch_scc1 L_o_loop2
    ds_read_b128 a[192:195], v226 offset:0
    ds_read_b128 a[196:199], v226 offset:1024
    v_mfma_f32_16x16x32_bf16 v[76:79], a[168:171], a[96:99], 0
    ds_read_b128 a[200:203], v226 offset:2048
    ds_read_b128 a[204:207], v226 offset:3072
    v_mfma_f32_16x16x32_bf16 v[76:79], a[172:175], a[100:103], v[76:79]
    ds_read_b128 a[208:211], v226 offset:4096
    ds_read_b128 a[212:215], v226 offset:5120
    v_mfma_f32_16x16x32_bf16 v[76:79], a[176:179], a[104:107], v[76:79]
    ds_read_b128 a[216:219], v226 offset:6144
    ds_read_b128 a[220:223], v226 offset:7168
    v_mfma_f32_16x16x32_bf16 v[76:79], a[180:183], a[108:111], v[76:79]
    v_xor_b32 v226, 0x2000, v226
    s_mul_i32 s51, s21, 256
    s_add_u32 s51, s22, s51
    v_mfma_f32_16x16x32_bf16 v[76:79], a[184:187], a[112:115], v[76:79]
    s_sub_u32 s51, s51, 512
    s_mul_hi_u32 s49, s51, 89478486
    s_mul_i32 s50, s49, 48
    s_sub_u32 s50, s51, s50
    v_mfma_f32_16x16x32_bf16 v[76:79], a[188:191], a[116:119], v[76:79]
    s_mul_i32 s49, s49, 1179648
    s_mul_i32 s50, s50, 3072
    s_add_u32 s33, s49, s50
    v_mfma_f32_16x16x32_bf16 v[92:95], a[168:171], a[120:123], 0
    v_mfma_f32_16x16x32_bf16 v[92:95], a[172:175], a[124:127], v[92:95]
    v_mfma_f32_16x16x32_bf16 v[92:95], a[176:179], a[128:131], v[92:95]
    v_mfma_f32_16x16x32_bf16 v[92:95], a[180:183], a[132:135], v[92:95]
    v_mfma_f32_16x16x32_bf16 v[92:95], a[184:187], a[136:139], v[92:95]
    v_mfma_f32_16x16x32_bf16 v[92:95], a[188:191], a[140:143], v[92:95]
    s_waitcnt lgkmcnt(7)
    v_mfma_f32_16x16x32_bf16 v[144:147], v[96:99], a[192:195], 0
    s_waitcnt lgkmcnt(6)
    v_mfma_f32_16x16x32_bf16 v[144:147], v[100:103], a[196:199], v[144:147]
    s_waitcnt lgkmcnt(5)
    v_mfma_f32_16x16x32_bf16 v[148:151], v[96:99], a[200:203], 0
    s_waitcnt lgkmcnt(4)
    v_mfma_f32_16x16x32_bf16 v[148:151], v[100:103], a[204:207], v[148:151]
    s_waitcnt lgkmcnt(3)
    v_mfma_f32_16x16x32_bf16 v[152:155], v[96:99], a[208:211], 0
    s_waitcnt lgkmcnt(2)
    v_mfma_f32_16x16x32_bf16 v[152:155], v[100:103], a[212:215], v[152:155]
    v_cvt_pk_bf16_f32 v208, v144, v145
    v_cvt_pk_bf16_f32 v209, v146, v147
    s_waitcnt lgkmcnt(1)
    v_mfma_f32_16x16x32_bf16 v[156:159], v[96:99], a[216:219], 0
    v_cvt_pk_bf16_f32 v96, v0, v1
    v_cvt_pk_bf16_f32 v97, v2, v3
    s_waitcnt lgkmcnt(0)
    v_mfma_f32_16x16x32_bf16 v[156:159], v[100:103], a[220:223], v[156:159]
    v_cvt_pk_bf16_f32 v98, v4, v5
    v_cvt_pk_bf16_f32 v99, v6, v7
    v_mfma_f32_16x16x32_bf16 v[160:163], v[104:107], a[192:195], 0
    v_cvt_pk_bf16_f32 v100, v8, v9
    v_cvt_pk_bf16_f32 v101, v10, v11
    v_mfma_f32_16x16x32_bf16 v[160:163], v[108:111], a[196:199], v[160:163]
    v_cvt_pk_bf16_f32 v102, v12, v13
    v_cvt_pk_bf16_f32 v103, v14, v15
    v_mfma_f32_16x16x32_bf16 v[164:167], v[104:107], a[200:203], 0
    v_cvt_pk_bf16_f32 v212, v148, v149
    v_cvt_pk_bf16_f32 v213, v150, v151
    v_mfma_f32_16x16x32_bf16 v[164:167], v[108:111], a[204:207], v[164:167]
    v_cvt_pk_bf16_f32 v216, v152, v153
    v_cvt_pk_bf16_f32 v217, v154, v155
    v_mfma_f32_16x16x32_bf16 v[168:171], v[104:107], a[208:211], 0
    v_cvt_pk_bf16_f32 v220, v156, v157
    v_cvt_pk_bf16_f32 v221, v158, v159
    v_mfma_f32_16x16x32_bf16 v[168:171], v[108:111], a[212:215], v[168:171]
    v_cvt_pk_bf16_f32 v210, v160, v161
    v_cvt_pk_bf16_f32 v211, v162, v163
    ds_write_b128 v233, v[208:211] offset:0
    v_mfma_f32_16x16x32_bf16 v[172:175], v[104:107], a[216:219], 0
    v_cvt_pk_bf16_f32 v104, v16, v17
    v_cvt_pk_bf16_f32 v105, v18, v19
    v_cvt_pk_bf16_f32 v106, v20, v21
    v_cvt_pk_bf16_f32 v107, v22, v23
    v_mfma_f32_16x16x32_bf16 v[172:175], v[108:111], a[220:223], v[172:175]
    v_cvt_pk_bf16_f32 v108, v24, v25
    v_cvt_pk_bf16_f32 v109, v26, v27
    v_cvt_pk_bf16_f32 v110, v28, v29
    v_mfma_f32_16x16x32_bf16 v[176:179], v[112:115], a[192:195], 0
    v_cvt_pk_bf16_f32 v111, v30, v31
    v_cvt_pk_bf16_f32 v214, v164, v165
    v_mfma_f32_16x16x32_bf16 v[176:179], v[116:119], a[196:199], v[176:179]
    v_cvt_pk_bf16_f32 v215, v166, v167
    ds_write_b128 v233, v[212:215] offset:3072
    v_mfma_f32_16x16x32_bf16 v[180:183], v[112:115], a[200:203], 0
    v_cvt_pk_bf16_f32 v218, v168, v169
    v_cvt_pk_bf16_f32 v219, v170, v171
    v_mfma_f32_16x16x32_bf16 v[180:183], v[116:119], a[204:207], v[180:183]
    ds_write_b128 v233, v[216:219] offset:6144
    v_cvt_pk_bf16_f32 v222, v172, v173
    v_mfma_f32_16x16x32_bf16 v[184:187], v[112:115], a[208:211], 0
    v_cvt_pk_bf16_f32 v223, v174, v175
    ds_write_b128 v233, v[220:223] offset:9216
    v_mfma_f32_16x16x32_bf16 v[184:187], v[116:119], a[212:215], v[184:187]
    v_cvt_pk_bf16_f32 v208, v176, v177
    v_cvt_pk_bf16_f32 v209, v178, v179
    v_mfma_f32_16x16x32_bf16 v[188:191], v[112:115], a[216:219], 0
    v_cvt_pk_bf16_f32 v112, v32, v33
    v_cvt_pk_bf16_f32 v113, v34, v35
    v_mfma_f32_16x16x32_bf16 v[188:191], v[116:119], a[220:223], v[188:191]
    v_cvt_pk_bf16_f32 v114, v36, v37
    v_cvt_pk_bf16_f32 v115, v38, v39
    v_mfma_f32_16x16x32_bf16 v[192:195], v[120:123], a[192:195], 0
    v_cvt_pk_bf16_f32 v116, v40, v41
    v_cvt_pk_bf16_f32 v117, v42, v43
    v_mfma_f32_16x16x32_bf16 v[192:195], v[124:127], a[196:199], v[192:195]
    v_cvt_pk_bf16_f32 v118, v44, v45
    v_cvt_pk_bf16_f32 v119, v46, v47
    v_mfma_f32_16x16x32_bf16 v[196:199], v[120:123], a[200:203], 0
    v_cvt_pk_bf16_f32 v212, v180, v181
    v_cvt_pk_bf16_f32 v213, v182, v183
    v_mfma_f32_16x16x32_bf16 v[196:199], v[124:127], a[204:207], v[196:199]
    v_cvt_pk_bf16_f32 v216, v184, v185
    v_cvt_pk_bf16_f32 v217, v186, v187
    v_mfma_f32_16x16x32_bf16 v[200:203], v[120:123], a[208:211], 0
    v_cvt_pk_bf16_f32 v220, v188, v189
    v_cvt_pk_bf16_f32 v221, v190, v191
    v_mfma_f32_16x16x32_bf16 v[200:203], v[124:127], a[212:215], v[200:203]
    v_cvt_pk_bf16_f32 v210, v192, v193
    v_cvt_pk_bf16_f32 v211, v194, v195
    ds_write_b128 v233, v[208:211] offset:64
    v_mfma_f32_16x16x32_bf16 v[204:207], v[120:123], a[216:219], 0
    v_cvt_pk_bf16_f32 v120, v48, v49
    v_cvt_pk_bf16_f32 v121, v50, v51
    v_cvt_pk_bf16_f32 v122, v52, v53
    v_cvt_pk_bf16_f32 v123, v54, v55
    v_mfma_f32_16x16x32_bf16 v[204:207], v[124:127], a[220:223], v[204:207]
    v_cvt_pk_bf16_f32 v124, v56, v57
    v_cvt_pk_bf16_f32 v125, v58, v59
    v_cvt_pk_bf16_f32 v126, v60, v61
    v_mfma_f32_16x16x32_bf16 v[144:147], v[128:131], a[192:195], 0
    v_cvt_pk_bf16_f32 v127, v62, v63
    v_cvt_pk_bf16_f32 v214, v196, v197
    v_mfma_f32_16x16x32_bf16 v[144:147], v[132:135], a[196:199], v[144:147]
    v_cvt_pk_bf16_f32 v215, v198, v199
    ds_write_b128 v233, v[212:215] offset:3136
    v_mfma_f32_16x16x32_bf16 v[148:151], v[128:131], a[200:203], 0
    v_cvt_pk_bf16_f32 v218, v200, v201
    v_cvt_pk_bf16_f32 v219, v202, v203
    v_mfma_f32_16x16x32_bf16 v[148:151], v[132:135], a[204:207], v[148:151]
    ds_write_b128 v233, v[216:219] offset:6208
    v_cvt_pk_bf16_f32 v222, v204, v205
    v_mfma_f32_16x16x32_bf16 v[152:155], v[128:131], a[208:211], 0
    v_cvt_pk_bf16_f32 v223, v206, v207
    ds_write_b128 v233, v[220:223] offset:9280
    v_mfma_f32_16x16x32_bf16 v[152:155], v[132:135], a[212:215], v[152:155]
    v_cvt_pk_bf16_f32 v208, v144, v145
    v_cvt_pk_bf16_f32 v209, v146, v147
    v_mfma_f32_16x16x32_bf16 v[156:159], v[128:131], a[216:219], 0
    v_cvt_pk_bf16_f32 v128, v64, v65
    v_cvt_pk_bf16_f32 v129, v66, v67
    v_mfma_f32_16x16x32_bf16 v[156:159], v[132:135], a[220:223], v[156:159]
    v_cvt_pk_bf16_f32 v130, v68, v69
    v_cvt_pk_bf16_f32 v131, v70, v71
    v_mfma_f32_16x16x32_bf16 v[160:163], v[136:139], a[192:195], 0
    v_cvt_pk_bf16_f32 v132, v72, v73
    v_cvt_pk_bf16_f32 v133, v74, v75
    v_mfma_f32_16x16x32_bf16 v[160:163], v[140:143], a[196:199], v[160:163]
    v_cvt_pk_bf16_f32 v134, v76, v77
    v_cvt_pk_bf16_f32 v135, v78, v79
    v_mfma_f32_16x16x32_bf16 v[164:167], v[136:139], a[200:203], 0
    v_cvt_pk_bf16_f32 v212, v148, v149
    v_cvt_pk_bf16_f32 v213, v150, v151
    v_mfma_f32_16x16x32_bf16 v[164:167], v[140:143], a[204:207], v[164:167]
    v_cvt_pk_bf16_f32 v216, v152, v153
    v_cvt_pk_bf16_f32 v217, v154, v155
    v_mfma_f32_16x16x32_bf16 v[168:171], v[136:139], a[208:211], 0
    v_cvt_pk_bf16_f32 v220, v156, v157
    v_cvt_pk_bf16_f32 v221, v158, v159
    v_mfma_f32_16x16x32_bf16 v[168:171], v[140:143], a[212:215], v[168:171]
    v_cvt_pk_bf16_f32 v210, v160, v161
    v_cvt_pk_bf16_f32 v211, v162, v163
    ds_write_b128 v233, v[208:211] offset:128
    v_mfma_f32_16x16x32_bf16 v[172:175], v[136:139], a[216:219], 0
    v_cvt_pk_bf16_f32 v136, v80, v81
    v_cvt_pk_bf16_f32 v137, v82, v83
    v_cvt_pk_bf16_f32 v138, v84, v85
    v_cvt_pk_bf16_f32 v139, v86, v87
    v_mfma_f32_16x16x32_bf16 v[172:175], v[140:143], a[220:223], v[172:175]
    v_cvt_pk_bf16_f32 v140, v88, v89
    v_cvt_pk_bf16_f32 v141, v90, v91
    v_cvt_pk_bf16_f32 v142, v92, v93
    v_cvt_pk_bf16_f32 v143, v94, v95
    v_cvt_pk_bf16_f32 v214, v164, v165
    v_cvt_pk_bf16_f32 v215, v166, v167
    ds_write_b128 v233, v[212:215] offset:3200
    v_cvt_pk_bf16_f32 v218, v168, v169
    v_cvt_pk_bf16_f32 v219, v170, v171
    ds_write_b128 v233, v[216:219] offset:6272
    v_cvt_pk_bf16_f32 v222, v172, v173
    v_cvt_pk_bf16_f32 v223, v174, v175
    ds_write_b128 v233, v[220:223] offset:9344
    s_barrier
    ds_read_b128 a[192:195], v226 offset:0
    ds_read_b128 a[196:199], v226 offset:1024
    ds_read_b128 a[200:203], v226 offset:2048
    ds_read_b128 a[204:207], v226 offset:3072
    ds_read_b128 a[208:211], v226 offset:4096
    ds_read_b128 a[212:215], v226 offset:5120
    ds_read_b128 a[216:219], v226 offset:6144
    ds_read_b128 a[220:223], v226 offset:7168
    ds_read_b128 a[224:227], v234 offset:0
    s_waitcnt lgkmcnt(8)
    v_mfma_f32_16x16x32_bf16 v[144:147], v[96:99], a[192:195], 0
    ds_read_b128 a[228:231], v235 offset:0
    ds_read_b128 a[232:235], v236 offset:0
    s_waitcnt lgkmcnt(9)
    v_mfma_f32_16x16x32_bf16 v[144:147], v[100:103], a[196:199], v[144:147]
    ds_read_b128 a[236:239], v234 offset:3072
    ds_read_b128 a[240:243], v235 offset:3072
    s_waitcnt lgkmcnt(10)
    v_mfma_f32_16x16x32_bf16 v[148:151], v[96:99], a[200:203], 0
    ds_read_b128 a[244:247], v236 offset:3072
    ds_read_b128 a[248:251], v234 offset:6144
    s_waitcnt lgkmcnt(11)
    v_mfma_f32_16x16x32_bf16 v[148:151], v[100:103], a[204:207], v[148:151]
    ds_read_b128 a[252:255], v235 offset:6144
    s_add_u32 s48, s33, 0
    s_waitcnt lgkmcnt(11)
    v_mfma_f32_16x16x32_bf16 v[152:155], v[96:99], a[208:211], 0
    s_add_u32 s21, s21, 1
    s_mul_i32 s51, s21, 256
    s_add_u32 s51, s22, s51
    s_sub_u32 s51, s51, 512
    s_waitcnt lgkmcnt(10)
    v_mfma_f32_16x16x32_bf16 v[152:155], v[100:103], a[212:215], v[152:155]
    s_mul_hi_u32 s49, s51, 89478486
    s_mul_i32 s50, s49, 48
    v_cvt_pk_bf16_f32 v208, v144, v145
    s_waitcnt lgkmcnt(9)
    v_mfma_f32_16x16x32_bf16 v[156:159], v[96:99], a[216:219], 0
    s_waitcnt lgkmcnt(7)
    buffer_store_dwordx4 a[224:227], v230, s[12:15], s48 offen offset:0 sc1
    v_mfma_f32_16x16x32_bf16 v[156:159], v[100:103], a[220:223], v[156:159]
    s_nop 0
    ds_read_b128 a[224:227], v236 offset:6144
    v_cvt_pk_bf16_f32 v209, v146, v147
    v_mfma_f32_16x16x32_bf16 v[160:163], v[104:107], a[192:195], 0
    s_waitcnt lgkmcnt(7)
    buffer_store_dwordx4 a[228:231], v231, s[12:15], s48 offen offset:0 sc1
    v_mfma_f32_16x16x32_bf16 v[160:163], v[108:111], a[196:199], v[160:163]
    s_waitcnt lgkmcnt(6)
    buffer_store_dwordx4 a[232:235], v232, s[12:15], s48 offen offset:0 sc1
    v_mfma_f32_16x16x32_bf16 v[164:167], v[104:107], a[200:203], 0
    ds_read_b128 a[228:231], v234 offset:9216
    s_add_u32 s48, s33, 294912
    s_sub_u32 s50, s51, s50
    v_mfma_f32_16x16x32_bf16 v[164:167], v[108:111], a[204:207], v[164:167]
    s_waitcnt lgkmcnt(6)
    buffer_store_dwordx4 a[236:239], v230, s[12:15], s48 offen offset:0 sc1
    v_mfma_f32_16x16x32_bf16 v[168:171], v[104:107], a[208:211], 0
    s_waitcnt lgkmcnt(5)
    buffer_store_dwordx4 a[240:243], v231, s[12:15], s48 offen offset:0 sc1
    v_mfma_f32_16x16x32_bf16 v[168:171], v[108:111], a[212:215], v[168:171]
    s_waitcnt lgkmcnt(4)
    buffer_store_dwordx4 a[244:247], v232, s[12:15], s48 offen offset:0 sc1
    v_mfma_f32_16x16x32_bf16 v[172:175], v[104:107], a[216:219], 0
    ds_read_b128 a[232:235], v235 offset:9216
    s_add_u32 s48, s33, 589824
    s_mul_i32 s49, s49, 1179648
    v_mfma_f32_16x16x32_bf16 v[172:175], v[108:111], a[220:223], v[172:175]
    s_waitcnt lgkmcnt(4)
    buffer_store_dwordx4 a[248:251], v230, s[12:15], s48 offen offset:0 sc1
    v_mfma_f32_16x16x32_bf16 v[176:179], v[112:115], a[192:195], 0
    s_waitcnt lgkmcnt(3)
    buffer_store_dwordx4 a[252:255], v231, s[12:15], s48 offen offset:0 sc1
    v_mfma_f32_16x16x32_bf16 v[176:179], v[116:119], a[196:199], v[176:179]
    ds_read_b128 a[236:239], v236 offset:9216
    v_cvt_pk_bf16_f32 v212, v148, v149
    v_mfma_f32_16x16x32_bf16 v[180:183], v[112:115], a[200:203], 0
    v_cvt_pk_bf16_f32 v213, v150, v151
    v_cvt_pk_bf16_f32 v216, v152, v153
    v_mfma_f32_16x16x32_bf16 v[180:183], v[116:119], a[204:207], v[180:183]
    v_cvt_pk_bf16_f32 v217, v154, v155
    v_cvt_pk_bf16_f32 v220, v156, v157
    v_mfma_f32_16x16x32_bf16 v[184:187], v[112:115], a[208:211], 0
    s_waitcnt lgkmcnt(3)
    buffer_store_dwordx4 a[224:227], v232, s[12:15], s48 offen offset:0 sc1
    v_mfma_f32_16x16x32_bf16 v[184:187], v[116:119], a[212:215], v[184:187]
    s_add_u32 s48, s33, 884736
    s_mul_i32 s50, s50, 3072
    v_cvt_pk_bf16_f32 v221, v158, v159
    v_mfma_f32_16x16x32_bf16 v[188:191], v[112:115], a[216:219], 0
    s_waitcnt lgkmcnt(2)
    buffer_store_dwordx4 a[228:231], v230, s[12:15], s48 offen offset:0 sc1
    v_mfma_f32_16x16x32_bf16 v[188:191], v[116:119], a[220:223], v[188:191]
    s_waitcnt lgkmcnt(1)
    buffer_store_dwordx4 a[232:235], v231, s[12:15], s48 offen offset:0 sc1
    v_mfma_f32_16x16x32_bf16 v[192:195], v[120:123], a[192:195], 0
    s_waitcnt lgkmcnt(0)
    buffer_store_dwordx4 a[236:239], v232, s[12:15], s48 offen offset:0 sc1
    v_mfma_f32_16x16x32_bf16 v[192:195], v[124:127], a[196:199], v[192:195]
    v_cvt_pk_bf16_f32 v210, v160, v161
    v_cvt_pk_bf16_f32 v211, v162, v163
    v_mfma_f32_16x16x32_bf16 v[196:199], v[120:123], a[200:203], 0
    s_add_u32 s33, s49, s50
    ds_write_b128 v233, v[208:211] offset:0
    s_add_u32 s48, s33, 0
    v_mfma_f32_16x16x32_bf16 v[196:199], v[124:127], a[204:207], v[196:199]
    v_cvt_pk_bf16_f32 v214, v164, v165
    v_cvt_pk_bf16_f32 v215, v166, v167
    v_mfma_f32_16x16x32_bf16 v[200:203], v[120:123], a[208:211], 0
    ds_write_b128 v233, v[212:215] offset:3072
    v_cvt_pk_bf16_f32 v218, v168, v169
    v_mfma_f32_16x16x32_bf16 v[200:203], v[124:127], a[212:215], v[200:203]
    v_cvt_pk_bf16_f32 v219, v170, v171
    ds_write_b128 v233, v[216:219] offset:6144
    v_mfma_f32_16x16x32_bf16 v[204:207], v[120:123], a[216:219], 0
    v_cvt_pk_bf16_f32 v222, v172, v173
    v_cvt_pk_bf16_f32 v223, v174, v175
    v_mfma_f32_16x16x32_bf16 v[204:207], v[124:127], a[220:223], v[204:207]
    ds_write_b128 v233, v[220:223] offset:9216
    v_cvt_pk_bf16_f32 v208, v176, v177
    v_mfma_f32_16x16x32_bf16 v[144:147], v[128:131], a[192:195], 0
    v_cvt_pk_bf16_f32 v209, v178, v179
    v_cvt_pk_bf16_f32 v212, v180, v181
    v_mfma_f32_16x16x32_bf16 v[144:147], v[132:135], a[196:199], v[144:147]
    v_cvt_pk_bf16_f32 v213, v182, v183
    v_cvt_pk_bf16_f32 v216, v184, v185
    v_mfma_f32_16x16x32_bf16 v[148:151], v[128:131], a[200:203], 0
    v_cvt_pk_bf16_f32 v217, v186, v187
    v_cvt_pk_bf16_f32 v220, v188, v189
    v_mfma_f32_16x16x32_bf16 v[148:151], v[132:135], a[204:207], v[148:151]
    v_cvt_pk_bf16_f32 v210, v192, v193
    v_cvt_pk_bf16_f32 v221, v190, v191
    v_mfma_f32_16x16x32_bf16 v[152:155], v[128:131], a[208:211], 0
    v_cvt_pk_bf16_f32 v211, v194, v195
    ds_write_b128 v233, v[208:211] offset:64
    v_mfma_f32_16x16x32_bf16 v[152:155], v[132:135], a[212:215], v[152:155]
    v_cvt_pk_bf16_f32 v214, v196, v197
    v_cvt_pk_bf16_f32 v215, v198, v199
    v_mfma_f32_16x16x32_bf16 v[156:159], v[128:131], a[216:219], 0
    ds_write_b128 v233, v[212:215] offset:3136
    v_cvt_pk_bf16_f32 v218, v200, v201
    v_mfma_f32_16x16x32_bf16 v[156:159], v[132:135], a[220:223], v[156:159]
    v_cvt_pk_bf16_f32 v219, v202, v203
    ds_write_b128 v233, v[216:219] offset:6208
    v_mfma_f32_16x16x32_bf16 v[160:163], v[136:139], a[192:195], 0
    v_cvt_pk_bf16_f32 v222, v204, v205
    v_cvt_pk_bf16_f32 v223, v206, v207
    v_mfma_f32_16x16x32_bf16 v[160:163], v[140:143], a[196:199], v[160:163]
    ds_write_b128 v233, v[220:223] offset:9280
    v_cvt_pk_bf16_f32 v208, v144, v145
    v_mfma_f32_16x16x32_bf16 v[164:167], v[136:139], a[200:203], 0
    v_cvt_pk_bf16_f32 v209, v146, v147
    v_cvt_pk_bf16_f32 v212, v148, v149
    v_mfma_f32_16x16x32_bf16 v[164:167], v[140:143], a[204:207], v[164:167]
    v_cvt_pk_bf16_f32 v213, v150, v151
    v_cvt_pk_bf16_f32 v216, v152, v153
    v_mfma_f32_16x16x32_bf16 v[168:171], v[136:139], a[208:211], 0
    v_cvt_pk_bf16_f32 v217, v154, v155
    v_cvt_pk_bf16_f32 v220, v156, v157
    v_mfma_f32_16x16x32_bf16 v[168:171], v[140:143], a[212:215], v[168:171]
    v_cvt_pk_bf16_f32 v210, v160, v161
    v_cvt_pk_bf16_f32 v221, v158, v159
    v_mfma_f32_16x16x32_bf16 v[172:175], v[136:139], a[216:219], 0
    v_cvt_pk_bf16_f32 v211, v162, v163
    ds_write_b128 v233, v[208:211] offset:128
    v_mfma_f32_16x16x32_bf16 v[172:175], v[140:143], a[220:223], v[172:175]
    v_cvt_pk_bf16_f32 v214, v164, v165
    v_cvt_pk_bf16_f32 v215, v166, v167
    ds_write_b128 v233, v[212:215] offset:3200
    v_cvt_pk_bf16_f32 v218, v168, v169
    v_cvt_pk_bf16_f32 v219, v170, v171
    ds_write_b128 v233, v[216:219] offset:6272
    s_nop 1
    v_cvt_pk_bf16_f32 v222, v172, v173
    v_cvt_pk_bf16_f32 v223, v174, v175
    ds_write_b128 v233, v[220:223] offset:9344
    ds_read_b128 a[224:227], v234 offset:0
    ds_read_b128 a[228:231], v235 offset:0
    ds_read_b128 a[232:235], v236 offset:0
    ds_read_b128 a[236:239], v234 offset:3072
    ds_read_b128 a[240:243], v235 offset:3072
    ds_read_b128 a[244:247], v236 offset:3072
    ds_read_b128 a[248:251], v234 offset:6144
    ds_read_b128 a[252:255], v235 offset:6144
    s_waitcnt lgkmcnt(7)
    buffer_store_dwordx4 a[224:227], v230, s[12:15], s48 offen offset:0 sc1
    s_nop 1
    ds_read_b128 a[224:227], v236 offset:6144
    s_waitcnt lgkmcnt(7)
    buffer_store_dwordx4 a[228:231], v231, s[12:15], s48 offen offset:0 sc1
    s_nop 1
    ds_read_b128 a[228:231], v234 offset:9216
    s_waitcnt lgkmcnt(7)
    buffer_store_dwordx4 a[232:235], v232, s[12:15], s48 offen offset:0 sc1
    s_nop 1
    ds_read_b128 a[232:235], v235 offset:9216
    s_add_u32 s48, s33, 294912
    s_waitcnt lgkmcnt(7)
    buffer_store_dwordx4 a[236:239], v230, s[12:15], s48 offen offset:0 sc1
    s_nop 1
    ds_read_b128 a[236:239], v236 offset:9216
    s_waitcnt lgkmcnt(7)
    buffer_store_dwordx4 a[240:243], v231, s[12:15], s48 offen offset:0 sc1
    s_waitcnt lgkmcnt(6)
    buffer_store_dwordx4 a[244:247], v232, s[12:15], s48 offen offset:0 sc1
    s_add_u32 s48, s33, 589824
    s_waitcnt lgkmcnt(5)
    buffer_store_dwordx4 a[248:251], v230, s[12:15], s48 offen offset:0 sc1
    s_waitcnt lgkmcnt(4)
    buffer_store_dwordx4 a[252:255], v231, s[12:15], s48 offen offset:0 sc1
    s_waitcnt lgkmcnt(3)
    buffer_store_dwordx4 a[224:227], v232, s[12:15], s48 offen offset:0 sc1
    s_add_u32 s48, s33, 884736
    s_waitcnt lgkmcnt(2)
    buffer_store_dwordx4 a[228:231], v230, s[12:15], s48 offen offset:0 sc1
    s_waitcnt lgkmcnt(1)
    buffer_store_dwordx4 a[232:235], v231, s[12:15], s48 offen offset:0 sc1
    s_waitcnt lgkmcnt(0)
    buffer_store_dwordx4 a[236:239], v232, s[12:15], s48 offen offset:0 sc1
L_end:
    s_endpgm
.globl swin_fold_kernel
.p2align 8
.type swin_fold_kernel,@function
swin_fold_kernel:
    s_cmp_ge_u32 s2, 144
    s_cbranch_scc1 L_fold_end
    s_load_dwordx4 s[4:7], s[0:1], 8
    s_load_dwordx2 s[24:25], s[0:1], 40
    s_cmp_ge_u32 s2, 72
    s_cselect_b32 s26, 1, 0
    s_mul_i32 s27, s26, 72
    s_sub_u32 s27, s2, s27
    s_mul_i32 s28, s27, 43
    s_lshr_b32 s28, s28, 8
    s_mul_i32 s29, s28, 6
    s_sub_u32 s29, s27, s29
    v_and_b32 v1, 15, v0
    v_lshrrev_b32 v2, 4, v0
    v_lshrrev_b32 v3, 2, v1
    v_lshlrev_b32 v3, 3, v3
    v_and_b32 v4, 3, v1
    v_or_b32 v3, v3, v4
    v_lshlrev_b32 v6, 4, v2
    s_waitcnt lgkmcnt(0)
    s_mov_b32 s8, s4
    s_and_b32 s9, s5, 0xffff
    s_mov_b32 s10, 221184
    s_mov_b32 s11, 0x00020000
    s_mov_b32 s12, s6
    s_and_b32 s13, s7, 0xffff
    s_mov_b32 s14, 73728
    s_mov_b32 s15, 0x00020000
    s_mov_b32 s16, s24
    s_and_b32 s17, s25, 0xffff
    s_mov_b32 s18, 147456
    s_mov_b32 s19, 0x00020000
    s_lshl_b32 s30, s29, 5
    v_add_u32 v5, s30, v3
    v_mul_u32_u24 v5, 1152, v5
    v_add_u32 v5, v5, v6
    s_mul_i32 s31, s26, 768
    v_add_u32 v5, s31, v5
    v_add_u32 v11, 4608, v5
    buffer_load_dwordx4 v[16:19], v5, s[8:11], 0 offen offset:0
    buffer_load_dwordx4 v[40:43], v11, s[8:11], 0 offen offset:0
    buffer_load_dwordx4 v[20:23], v5, s[8:11], 0 offen offset:64
    buffer_load_dwordx4 v[44:47], v11, s[8:11], 0 offen offset:64
    buffer_load_dwordx4 v[24:27], v5, s[8:11], 0 offen offset:128
    buffer_load_dwordx4 v[48:51], v11, s[8:11], 0 offen offset:128
    buffer_load_dwordx4 v[28:31], v5, s[8:11], 0 offen offset:192
    buffer_load_dwordx4 v[52:55], v11, s[8:11], 0 offen offset:192
    buffer_load_dwordx4 v[32:35], v5, s[8:11], 0 offen offset:256
    buffer_load_dwordx4 v[56:59], v11, s[8:11], 0 offen offset:256
    buffer_load_dwordx4 v[36:39], v5, s[8:11], 0 offen offset:320
    buffer_load_dwordx4 v[60:63], v11, s[8:11], 0 offen offset:320
    s_lshr_b32 s30, s28, 1
    s_lshl_b32 s30, s30, 5
    s_and_b32 s31, s28, 1
    s_lshl_b32 s31, s31, 2
    s_add_u32 s30, s30, s31
    v_add_u32 v7, s30, v3
    s_cmp_eq_u32 s26, 1
    s_cbranch_scc1 L_fold_wo
    v_mul_u32_u24 v8, 1152, v7
    v_add_u32 v8, v8, v6
    v_add_u32 v8, 384, v8
    buffer_load_dwordx4 v[64:67], v8, s[8:11], 0 offen offset:0
    buffer_load_dwordx4 v[68:71], v8, s[8:11], 0 offen offset:64
    buffer_load_dwordx4 v[72:75], v8, s[8:11], 0 offen offset:128
    buffer_load_dwordx4 v[76:79], v8, s[8:11], 0 offen offset:192
    buffer_load_dwordx4 v[80:83], v8, s[8:11], 0 offen offset:256
    buffer_load_dwordx4 v[84:87], v8, s[8:11], 0 offen offset:320
    s_getpc_b64 s[40:41]
L_fold_pca:
    s_sub_u32 s40, s40, L_fold_pca-standalone__swin_window_attn__vision_kernel
    s_subb_u32 s41, s41, 0
    v_lshlrev_b32 v13, 4, v0
    v_add_u32 v12, 0, v13
    v_min_u32 v12, swin_fold_kernel-standalone__swin_window_attn__vision_kernel-16, v12
    global_load_dwordx4 v[144:147], v12, s[40:41]
    v_add_u32 v12, 1024, v13
    v_min_u32 v12, swin_fold_kernel-standalone__swin_window_attn__vision_kernel-16, v12
    global_load_dwordx4 v[144:147], v12, s[40:41]
    v_add_u32 v12, 2048, v13
    v_min_u32 v12, swin_fold_kernel-standalone__swin_window_attn__vision_kernel-16, v12
    global_load_dwordx4 v[144:147], v12, s[40:41]
    v_add_u32 v12, 3072, v13
    v_min_u32 v12, swin_fold_kernel-standalone__swin_window_attn__vision_kernel-16, v12
    global_load_dwordx4 v[144:147], v12, s[40:41]
    v_add_u32 v12, 4096, v13
    v_min_u32 v12, swin_fold_kernel-standalone__swin_window_attn__vision_kernel-16, v12
    global_load_dwordx4 v[144:147], v12, s[40:41]
    v_add_u32 v12, 5120, v13
    v_min_u32 v12, swin_fold_kernel-standalone__swin_window_attn__vision_kernel-16, v12
    global_load_dwordx4 v[144:147], v12, s[40:41]
    v_add_u32 v12, 6144, v13
    v_min_u32 v12, swin_fold_kernel-standalone__swin_window_attn__vision_kernel-16, v12
    global_load_dwordx4 v[144:147], v12, s[40:41]
    v_add_u32 v12, 7168, v13
    v_min_u32 v12, swin_fold_kernel-standalone__swin_window_attn__vision_kernel-16, v12
    global_load_dwordx4 v[144:147], v12, s[40:41]
    v_add_u32 v12, 8192, v13
    v_min_u32 v12, swin_fold_kernel-standalone__swin_window_attn__vision_kernel-16, v12
    global_load_dwordx4 v[144:147], v12, s[40:41]
    v_add_u32 v12, 9216, v13
    v_min_u32 v12, swin_fold_kernel-standalone__swin_window_attn__vision_kernel-16, v12
    global_load_dwordx4 v[144:147], v12, s[40:41]
    v_add_u32 v12, 10240, v13
    v_min_u32 v12, swin_fold_kernel-standalone__swin_window_attn__vision_kernel-16, v12
    global_load_dwordx4 v[144:147], v12, s[40:41]
    v_add_u32 v12, 11264, v13
    v_min_u32 v12, swin_fold_kernel-standalone__swin_window_attn__vision_kernel-16, v12
    global_load_dwordx4 v[144:147], v12, s[40:41]
    v_add_u32 v12, 12288, v13
    v_min_u32 v12, swin_fold_kernel-standalone__swin_window_attn__vision_kernel-16, v12
    global_load_dwordx4 v[144:147], v12, s[40:41]
    v_add_u32 v12, 13312, v13
    v_min_u32 v12, swin_fold_kernel-standalone__swin_window_attn__vision_kernel-16, v12
    global_load_dwordx4 v[144:147], v12, s[40:41]
    v_add_u32 v12, 14336, v13
    v_min_u32 v12, swin_fold_kernel-standalone__swin_window_attn__vision_kernel-16, v12
    global_load_dwordx4 v[144:147], v12, s[40:41]
    v_add_u32 v12, 15360, v13
    v_min_u32 v12, swin_fold_kernel-standalone__swin_window_attn__vision_kernel-16, v12
    global_load_dwordx4 v[144:147], v12, s[40:41]
    v_add_u32 v12, 16384, v13
    v_min_u32 v12, swin_fold_kernel-standalone__swin_window_attn__vision_kernel-16, v12
    global_load_dwordx4 v[144:147], v12, s[40:41]
    v_add_u32 v12, 17408, v13
    v_min_u32 v12, swin_fold_kernel-standalone__swin_window_attn__vision_kernel-16, v12
    global_load_dwordx4 v[144:147], v12, s[40:41]
    v_add_u32 v12, 18432, v13
    v_min_u32 v12, swin_fold_kernel-standalone__swin_window_attn__vision_kernel-16, v12
    global_load_dwordx4 v[144:147], v12, s[40:41]
    v_add_u32 v12, 19456, v13
    v_min_u32 v12, swin_fold_kernel-standalone__swin_window_attn__vision_kernel-16, v12
    global_load_dwordx4 v[144:147], v12, s[40:41]
    v_add_u32 v12, 20480, v13
    v_min_u32 v12, swin_fold_kernel-standalone__swin_window_attn__vision_kernel-16, v12
    global_load_dwordx4 v[144:147], v12, s[40:41]
    v_add_u32 v12, 21504, v13
    v_min_u32 v12, swin_fold_kernel-standalone__swin_window_attn__vision_kernel-16, v12
    global_load_dwordx4 v[144:147], v12, s[40:41]
    v_add_u32 v12, 22528, v13
    v_min_u32 v12, swin_fold_kernel-standalone__swin_window_attn__vision_kernel-16, v12
    global_load_dwordx4 v[144:147], v12, s[40:41]
    v_add_u32 v12, 23552, v13
    v_min_u32 v12, swin_fold_kernel-standalone__swin_window_attn__vision_kernel-16, v12
    global_load_dwordx4 v[144:147], v12, s[40:41]
    v_add_u32 v12, 24576, v13
    v_min_u32 v12, swin_fold_kernel-standalone__swin_window_attn__vision_kernel-16, v12
    global_load_dwordx4 v[144:147], v12, s[40:41]
    v_add_u32 v12, 25600, v13
    v_min_u32 v12, swin_fold_kernel-standalone__swin_window_attn__vision_kernel-16, v12
    global_load_dwordx4 v[144:147], v12, s[40:41]
    v_add_u32 v12, 26624, v13
    v_min_u32 v12, swin_fold_kernel-standalone__swin_window_attn__vision_kernel-16, v12
    global_load_dwordx4 v[144:147], v12, s[40:41]
    v_add_u32 v12, 27648, v13
    v_min_u32 v12, swin_fold_kernel-standalone__swin_window_attn__vision_kernel-16, v12
    global_load_dwordx4 v[144:147], v12, s[40:41]
    s_waitcnt vmcnt(28)
    s_branch L_fold_mm
L_fold_wo:
    v_mul_u32_u24 v8, 3072, v2
    v_lshlrev_b32 v9, 1, v7
    v_add_u32 v8, v8, v9
    s_mov_b32 s32, 0
    buffer_load_ushort v96, v8, s[12:15], s32 offen offset:0
    buffer_load_ushort v97, v8, s[12:15], s32 offen offset:384
    buffer_load_ushort v98, v8, s[12:15], s32 offen offset:768
    buffer_load_ushort v99, v8, s[12:15], s32 offen offset:1152
    buffer_load_ushort v100, v8, s[12:15], s32 offen offset:1536
    buffer_load_ushort v101, v8, s[12:15], s32 offen offset:1920
    buffer_load_ushort v102, v8, s[12:15], s32 offen offset:2304
    buffer_load_ushort v103, v8, s[12:15], s32 offen offset:2688
    s_mov_b32 s32, 12288
    buffer_load_ushort v104, v8, s[12:15], s32 offen offset:0
    buffer_load_ushort v105, v8, s[12:15], s32 offen offset:384
    buffer_load_ushort v106, v8, s[12:15], s32 offen offset:768
    buffer_load_ushort v107, v8, s[12:15], s32 offen offset:1152
    buffer_load_ushort v108, v8, s[12:15], s32 offen offset:1536
    buffer_load_ushort v109, v8, s[12:15], s32 offen offset:1920
    buffer_load_ushort v110, v8, s[12:15], s32 offen offset:2304
    buffer_load_ushort v111, v8, s[12:15], s32 offen offset:2688
    s_mov_b32 s32, 24576
    buffer_load_ushort v112, v8, s[12:15], s32 offen offset:0
    buffer_load_ushort v113, v8, s[12:15], s32 offen offset:384
    buffer_load_ushort v114, v8, s[12:15], s32 offen offset:768
    buffer_load_ushort v115, v8, s[12:15], s32 offen offset:1152
    buffer_load_ushort v116, v8, s[12:15], s32 offen offset:1536
    buffer_load_ushort v117, v8, s[12:15], s32 offen offset:1920
    buffer_load_ushort v118, v8, s[12:15], s32 offen offset:2304
    buffer_load_ushort v119, v8, s[12:15], s32 offen offset:2688
    s_mov_b32 s32, 36864
    buffer_load_ushort v120, v8, s[12:15], s32 offen offset:0
    buffer_load_ushort v121, v8, s[12:15], s32 offen offset:384
    buffer_load_ushort v122, v8, s[12:15], s32 offen offset:768
    buffer_load_ushort v123, v8, s[12:15], s32 offen offset:1152
    buffer_load_ushort v124, v8, s[12:15], s32 offen offset:1536
    buffer_load_ushort v125, v8, s[12:15], s32 offen offset:1920
    buffer_load_ushort v126, v8, s[12:15], s32 offen offset:2304
    buffer_load_ushort v127, v8, s[12:15], s32 offen offset:2688
    s_mov_b32 s32, 49152
    buffer_load_ushort v128, v8, s[12:15], s32 offen offset:0
    buffer_load_ushort v129, v8, s[12:15], s32 offen offset:384
    buffer_load_ushort v130, v8, s[12:15], s32 offen offset:768
    buffer_load_ushort v131, v8, s[12:15], s32 offen offset:1152
    buffer_load_ushort v132, v8, s[12:15], s32 offen offset:1536
    buffer_load_ushort v133, v8, s[12:15], s32 offen offset:1920
    buffer_load_ushort v134, v8, s[12:15], s32 offen offset:2304
    buffer_load_ushort v135, v8, s[12:15], s32 offen offset:2688
    s_mov_b32 s32, 61440
    buffer_load_ushort v136, v8, s[12:15], s32 offen offset:0
    buffer_load_ushort v137, v8, s[12:15], s32 offen offset:384
    buffer_load_ushort v138, v8, s[12:15], s32 offen offset:768
    buffer_load_ushort v139, v8, s[12:15], s32 offen offset:1152
    buffer_load_ushort v140, v8, s[12:15], s32 offen offset:1536
    buffer_load_ushort v141, v8, s[12:15], s32 offen offset:1920
    buffer_load_ushort v142, v8, s[12:15], s32 offen offset:2304
    buffer_load_ushort v143, v8, s[12:15], s32 offen offset:2688
    s_waitcnt vmcnt(32)
    s_getpc_b64 s[40:41]
L_fold_pcb:
    s_sub_u32 s40, s40, L_fold_pcb-standalone__swin_window_attn__vision_kernel
    s_subb_u32 s41, s41, 0
    v_lshlrev_b32 v13, 4, v0
    v_add_u32 v12, 0, v13
    v_min_u32 v12, swin_fold_kernel-standalone__swin_window_attn__vision_kernel-16, v12
    global_load_dwordx4 v[144:147], v12, s[40:41]
    v_add_u32 v12, 1024, v13
    v_min_u32 v12, swin_fold_kernel-standalone__swin_window_attn__vision_kernel-16, v12
    global_load_dwordx4 v[144:147], v12, s[40:41]
    v_add_u32 v12, 2048, v13
    v_min_u32 v12, swin_fold_kernel-standalone__swin_window_attn__vision_kernel-16, v12
    global_load_dwordx4 v[144:147], v12, s[40:41]
    v_add_u32 v12, 3072, v13
    v_min_u32 v12, swin_fold_kernel-standalone__swin_window_attn__vision_kernel-16, v12
    global_load_dwordx4 v[144:147], v12, s[40:41]
    v_add_u32 v12, 4096, v13
    v_min_u32 v12, swin_fold_kernel-standalone__swin_window_attn__vision_kernel-16, v12
    global_load_dwordx4 v[144:147], v12, s[40:41]
    v_add_u32 v12, 5120, v13
    v_min_u32 v12, swin_fold_kernel-standalone__swin_window_attn__vision_kernel-16, v12
    global_load_dwordx4 v[144:147], v12, s[40:41]
    v_add_u32 v12, 6144, v13
    v_min_u32 v12, swin_fold_kernel-standalone__swin_window_attn__vision_kernel-16, v12
    global_load_dwordx4 v[144:147], v12, s[40:41]
    v_add_u32 v12, 7168, v13
    v_min_u32 v12, swin_fold_kernel-standalone__swin_window_attn__vision_kernel-16, v12
    global_load_dwordx4 v[144:147], v12, s[40:41]
    v_add_u32 v12, 8192, v13
    v_min_u32 v12, swin_fold_kernel-standalone__swin_window_attn__vision_kernel-16, v12
    global_load_dwordx4 v[144:147], v12, s[40:41]
    v_add_u32 v12, 9216, v13
    v_min_u32 v12, swin_fold_kernel-standalone__swin_window_attn__vision_kernel-16, v12
    global_load_dwordx4 v[144:147], v12, s[40:41]
    v_add_u32 v12, 10240, v13
    v_min_u32 v12, swin_fold_kernel-standalone__swin_window_attn__vision_kernel-16, v12
    global_load_dwordx4 v[144:147], v12, s[40:41]
    v_add_u32 v12, 11264, v13
    v_min_u32 v12, swin_fold_kernel-standalone__swin_window_attn__vision_kernel-16, v12
    global_load_dwordx4 v[144:147], v12, s[40:41]
    v_add_u32 v12, 12288, v13
    v_min_u32 v12, swin_fold_kernel-standalone__swin_window_attn__vision_kernel-16, v12
    global_load_dwordx4 v[144:147], v12, s[40:41]
    v_add_u32 v12, 13312, v13
    v_min_u32 v12, swin_fold_kernel-standalone__swin_window_attn__vision_kernel-16, v12
    global_load_dwordx4 v[144:147], v12, s[40:41]
    v_add_u32 v12, 14336, v13
    v_min_u32 v12, swin_fold_kernel-standalone__swin_window_attn__vision_kernel-16, v12
    global_load_dwordx4 v[144:147], v12, s[40:41]
    v_add_u32 v12, 15360, v13
    v_min_u32 v12, swin_fold_kernel-standalone__swin_window_attn__vision_kernel-16, v12
    global_load_dwordx4 v[144:147], v12, s[40:41]
    v_add_u32 v12, 16384, v13
    v_min_u32 v12, swin_fold_kernel-standalone__swin_window_attn__vision_kernel-16, v12
    global_load_dwordx4 v[144:147], v12, s[40:41]
    v_add_u32 v12, 17408, v13
    v_min_u32 v12, swin_fold_kernel-standalone__swin_window_attn__vision_kernel-16, v12
    global_load_dwordx4 v[144:147], v12, s[40:41]
    v_add_u32 v12, 18432, v13
    v_min_u32 v12, swin_fold_kernel-standalone__swin_window_attn__vision_kernel-16, v12
    global_load_dwordx4 v[144:147], v12, s[40:41]
    v_add_u32 v12, 19456, v13
    v_min_u32 v12, swin_fold_kernel-standalone__swin_window_attn__vision_kernel-16, v12
    global_load_dwordx4 v[144:147], v12, s[40:41]
    v_add_u32 v12, 20480, v13
    v_min_u32 v12, swin_fold_kernel-standalone__swin_window_attn__vision_kernel-16, v12
    global_load_dwordx4 v[144:147], v12, s[40:41]
    v_add_u32 v12, 21504, v13
    v_min_u32 v12, swin_fold_kernel-standalone__swin_window_attn__vision_kernel-16, v12
    global_load_dwordx4 v[144:147], v12, s[40:41]
    v_add_u32 v12, 22528, v13
    v_min_u32 v12, swin_fold_kernel-standalone__swin_window_attn__vision_kernel-16, v12
    global_load_dwordx4 v[144:147], v12, s[40:41]
    v_add_u32 v12, 23552, v13
    v_min_u32 v12, swin_fold_kernel-standalone__swin_window_attn__vision_kernel-16, v12
    global_load_dwordx4 v[144:147], v12, s[40:41]
    v_add_u32 v12, 24576, v13
    v_min_u32 v12, swin_fold_kernel-standalone__swin_window_attn__vision_kernel-16, v12
    global_load_dwordx4 v[144:147], v12, s[40:41]
    v_add_u32 v12, 25600, v13
    v_min_u32 v12, swin_fold_kernel-standalone__swin_window_attn__vision_kernel-16, v12
    global_load_dwordx4 v[144:147], v12, s[40:41]
    v_add_u32 v12, 26624, v13
    v_min_u32 v12, swin_fold_kernel-standalone__swin_window_attn__vision_kernel-16, v12
    global_load_dwordx4 v[144:147], v12, s[40:41]
    v_add_u32 v12, 27648, v13
    v_min_u32 v12, swin_fold_kernel-standalone__swin_window_attn__vision_kernel-16, v12
    global_load_dwordx4 v[144:147], v12, s[40:41]
    s_waitcnt vmcnt(28)
    v_lshl_or_b32 v64, v97, 16, v96
    v_lshl_or_b32 v65, v99, 16, v98
    v_lshl_or_b32 v66, v101, 16, v100
    v_lshl_or_b32 v67, v103, 16, v102
    v_lshl_or_b32 v68, v105, 16, v104
    v_lshl_or_b32 v69, v107, 16, v106
    v_lshl_or_b32 v70, v109, 16, v108
    v_lshl_or_b32 v71, v111, 16, v110
    v_lshl_or_b32 v72, v113, 16, v112
    v_lshl_or_b32 v73, v115, 16, v114
    v_lshl_or_b32 v74, v117, 16, v116
    v_lshl_or_b32 v75, v119, 16, v118
    v_lshl_or_b32 v76, v121, 16, v120
    v_lshl_or_b32 v77, v123, 16, v122
    v_lshl_or_b32 v78, v125, 16, v124
    v_lshl_or_b32 v79, v127, 16, v126
    v_lshl_or_b32 v80, v129, 16, v128
    v_lshl_or_b32 v81, v131, 16, v130
    v_lshl_or_b32 v82, v133, 16, v132
    v_lshl_or_b32 v83, v135, 16, v134
    v_lshl_or_b32 v84, v137, 16, v136
    v_lshl_or_b32 v85, v139, 16, v138
    v_lshl_or_b32 v86, v141, 16, v140
    v_lshl_or_b32 v87, v143, 16, v142
L_fold_mm:
    v_mfma_f32_16x16x32_bf16 v[88:91], v[16:19], v[64:67], 0
    v_mfma_f32_16x16x32_bf16 v[92:95], v[40:43], v[64:67], 0
    v_mfma_f32_16x16x32_bf16 v[88:91], v[20:23], v[68:71], v[88:91]
    v_mfma_f32_16x16x32_bf16 v[92:95], v[44:47], v[68:71], v[92:95]
    v_mfma_f32_16x16x32_bf16 v[88:91], v[24:27], v[72:75], v[88:91]
    v_mfma_f32_16x16x32_bf16 v[92:95], v[48:51], v[72:75], v[92:95]
    v_mfma_f32_16x16x32_bf16 v[88:91], v[28:31], v[76:79], v[88:91]
    v_mfma_f32_16x16x32_bf16 v[92:95], v[52:55], v[76:79], v[92:95]
    v_mfma_f32_16x16x32_bf16 v[88:91], v[32:35], v[80:83], v[88:91]
    v_mfma_f32_16x16x32_bf16 v[92:95], v[56:59], v[80:83], v[92:95]
    v_mfma_f32_16x16x32_bf16 v[88:91], v[36:39], v[84:87], v[88:91]
    v_mfma_f32_16x16x32_bf16 v[92:95], v[60:63], v[84:87], v[92:95]
    s_nop 6
    v_cvt_pk_bf16_f32 v16, v88, v89
    v_cvt_pk_bf16_f32 v17, v90, v91
    v_cvt_pk_bf16_f32 v18, v92, v93
    v_cvt_pk_bf16_f32 v19, v94, v95
    s_lshl_b32 s33, s27, 10
    s_mul_i32 s34, s26, 73728
    s_add_u32 s33, s33, s34
    v_lshlrev_b32 v10, 4, v0
    buffer_store_dwordx4 v[16:19], v10, s[16:19], s33 offen offset:0
L_fold_end:
    s_endpgm
.section .rodata,"a"
.p2align 6
L_kd_main:
.amdhsa_kernel standalone__swin_window_attn__vision_kernel
  .amdhsa_next_free_vgpr 512
  .amdhsa_next_free_sgpr 64
  .amdhsa_accum_offset 256
  .amdhsa_group_segment_fixed_size 0
  .amdhsa_kernarg_size 48
  .amdhsa_user_sgpr_count 2
  .amdhsa_user_sgpr_kernarg_segment_ptr 1
  .amdhsa_system_sgpr_workgroup_id_x 1
.end_amdhsa_kernel
.p2align 6
.amdhsa_kernel swin_fold_kernel
  .amdhsa_next_free_vgpr 160
  .amdhsa_next_free_sgpr 64
  .amdhsa_accum_offset 160
  .amdhsa_group_segment_fixed_size 0
  .amdhsa_kernarg_size 48
  .amdhsa_user_sgpr_count 2
  .amdhsa_user_sgpr_kernarg_segment_ptr 1
  .amdhsa_system_sgpr_workgroup_id_x 1
.end_amdhsa_kernel
```
